```python
import torch

def _softmax(x, axis=-1):
    return torch.softmax(x, dim=axis)
def _gelu(x):
    return torch.nn.functional.gelu(x, approximate="tanh")
def _silu(x):
    return torch.nn.functional.silu(x)
def _sigmoid(x):
    return torch.sigmoid(x)
def _layernorm(x, axis=-1, eps=1e-5):
    m = x.mean(dim=axis, keepdim=True)
    v = x.var(dim=axis, keepdim=True, unbiased=False)
    return (x - m) / torch.sqrt(v + eps)
def _scatter_add(tgt, idx, src, axis=0):
    return tgt.clone().index_add_(axis, idx, src)
def _segment_sum(src, seg, n):
    out = torch.zeros((n,) + src.shape[1:], dtype=src.dtype)
    return out.index_add_(0, seg, src)
def _pad(x, pw):
    flat = tuple(v for pair in reversed(pw) for v in pair)
    return torch.nn.functional.pad(x, flat)

kernel_name = 'sequential_preLN__mha_block_cached__glu_gated_bilinear__decode'

def setup_inputs():

    _w = (lambda a: (lambda t: t.to(torch.bfloat16) if t.is_floating_point() else t)(torch.as_tensor(a)))
    def _A_setup():
        B, Sq, D = 2, 1, 640
        H, Sk, Dh = 32, 4096, 128
        return {
            "x": _w((lambda *s: torch.randn(*s, dtype=torch.bfloat16) * 0.05)(B, Sq, D)),
            "k_cache": _w((lambda *s: torch.randn(*s, dtype=torch.bfloat16) * 1.6)(B, H, Sk, Dh)),
            "v_cache": _w((lambda *s: torch.randn(*s, dtype=torch.bfloat16) * 0.8)(B, H, Sk, Dh)),
            "wq": _w((lambda *s: torch.randn(*s, dtype=torch.bfloat16) * 1.6)(D, H * Dh) * (D ** -0.5)),
            "wo": _w((lambda *s: torch.randn(*s, dtype=torch.bfloat16) * 0.8)(H * Dh, D) * ((H * Dh) ** -0.5)),
        }
    _A_in = _A_setup()

    def _B_setup():
        B, S, D, F = 2, 1, 640, 1728
        return {
            "x": _w((lambda *s: torch.randn(*s, dtype=torch.bfloat16) * 0.05)(B, S, D)),
            "w_gate": _w((lambda *s: torch.randn(*s, dtype=torch.bfloat16) * 0.4)(D, F) * (D ** -0.5)),
            "w_up": _w((lambda *s: torch.randn(*s, dtype=torch.bfloat16) * 0.4)(D, F) * (D ** -0.5)),
            "w_down": _w((lambda *s: torch.randn(*s, dtype=torch.bfloat16) * 0.4)(F, D) * (F ** -0.5)),
        }
    _B_in = _B_setup()

    return {
        "A_x": _A_in["x"],
        "A_k_cache": _A_in["k_cache"],
        "A_v_cache": _A_in["v_cache"],
        "A_wq": _A_in["wq"],
        "A_wo": _A_in["wo"],
        "B_x": _B_in["x"],
        "B_w_gate": _B_in["w_gate"],
        "B_w_up": _B_in["w_up"],
        "B_w_down": _B_in["w_down"],
    }

def reference(A_x, A_k_cache, A_v_cache, A_wq, A_wo, B_x, B_w_gate, B_w_up, B_w_down):
    def _A_ref(x, k_cache, v_cache, wq, wo):
        B, Sq, D = x.shape
        H, Dh = 32, 128
        q = (lambda x, *d: x.permute(*d))((x @ wq).reshape(B, Sq, H, Dh), 0, 2, 1, 3)
        scores = torch.einsum("bhqd,bhkd->bhqk", q, k_cache) * (Dh ** -0.5)
        p = _softmax(scores, axis=-1)
        o = torch.einsum("bhqk,bhkd->bhqd", p, v_cache)
        return (lambda x, *d: x.permute(*d))(o, 0, 2, 1, 3).reshape(B, Sq, H * Dh) @ wo

    def _B_ref(x, w_gate, w_up, w_down):
        g = torch.einsum("bsd,df->bsf", x, w_gate)
        u = torch.einsum("bsd,df->bsf", x, w_up)
        h = g * u
        return torch.einsum("bsf,fd->bsd", h, w_down)

    x = A_x
    h = x + _A_ref(_layernorm(x, axis=-1), A_k_cache, A_v_cache, A_wq, A_wo)
    h2 = h + _B_ref(_layernorm(h, axis=-1), B_w_gate, B_w_up, B_w_down)
    return h2
```

```asm
; @launch grid=(256,1,1) block=(512,1,1) lds=69632
.amdgcn_target "amdgcn-amd-amdhsa--gfx950"
.text
.globl sequential_preLN__mha_block_cached__glu_gated_bilinear__decode_kernel
.p2align 8
.type sequential_preLN__mha_block_cached__glu_gated_bilinear__decode_kernel,@function
sequential_preLN__mha_block_cached__glu_gated_bilinear__decode_kernel:
  s_cmp_ge_u32 s2, 256
  s_cbranch_scc1 L_end
  s_load_dwordx4 s[4:7], s[0:1], 0
  s_load_dwordx4 s[8:11], s[0:1], 16
  s_load_dwordx8 s[12:19], s[0:1], 32
  s_load_dwordx8 s[20:27], s[0:1], 64
  v_lshrrev_b32 v16, 6, v0
  v_and_b32 v1, 63, v0
  v_readfirstlane_b32 s3, v16
  v_lshlrev_b32 v2, 4, v1
  s_and_b32 s90, s2, 7
  s_lshr_b32 s91, s2, 3
  s_lshr_b32 s92, s91, 3
  s_lshl_b32 s64, s90, 2
  s_add_u32 s64, s64, s92
  s_and_b32 s67, s91, 7
  s_lshr_b32 s65, s67, 2
  s_and_b32 s66, s67, 3
  s_lshl_b32 s92, s65, 5
  s_add_u32 s92, s92, s64
  s_lshl_b32 s92, s92, 20
  s_lshl_b32 s93, s66, 18
  s_add_u32 s92, s92, s93
  s_sub_u32 s93, s3, 1
  s_cmp_eq_u32 s3, 0
  s_cselect_b32 s93, 252, s93
  s_lshl_b32 s93, s93, 10
  s_add_u32 s92, s92, s93
  s_sub_u32 s30, 0x40000, s93
  s_mov_b32 s31, 0x00020000
  s_mov_b32 s69, 0
  s_mov_b32 s70, s69
  s_waitcnt lgkmcnt(0)
  s_add_u32 s28, s6, s92
  s_addc_u32 s29, s7, 0
  s_cmp_eq_u32 s3, 0
  s_cbranch_scc1 L_nopre
  buffer_load_dwordx4 v[100:103], v2, s[28:31], s69 offen nt
  s_add_u32 s69, s69, 7168
  buffer_load_dwordx4 v[104:107], v2, s[28:31], s69 offen nt
  s_add_u32 s69, s69, 7168
  buffer_load_dwordx4 v[108:111], v2, s[28:31], s69 offen nt
  s_add_u32 s69, s69, 7168
  buffer_load_dwordx4 v[112:115], v2, s[28:31], s69 offen nt
  s_add_u32 s69, s69, 7168
L_nopre:
  s_add_u32 s32, s8, s92
  s_addc_u32 s33, s9, 0
  s_mov_b32 s34, s30
  s_mov_b32 s35, 0x00020000
  v_and_b32 v3, 15, v1
  v_lshrrev_b32 v4, 4, v1
  s_lshl_b32 s68, s64, 3
  s_add_u32 s68, s68, s67
  s_mov_b32 s71, 0
  s_sub_u32 s78, s64, 27
  s_cmp_lt_u32 s64, 27
  s_cselect_b32 s77, 1, 0
  s_cselect_b32 s78, 0, s78
  s_mov_b32 s82, 0xcccccccc
  s_mov_b32 s83, 0xcccccccc
  s_mov_b32 s84, 0xaaaaaaaa
  s_mov_b32 s85, 0xaaaaaaaa
  v_mov_b32 v11, 0x7fc00000
  v_mov_b32 v246, 0x10101010
  s_getreg_b32 s79, hwreg(HW_REG_XCC_ID)
  s_and_b32 s79, s79, 0xf
  s_cmp_eq_u32 s3, 0
  s_cbranch_scc1 L_w0
  s_barrier
  s_cmp_ge_u32 s3, 4
  s_cbranch_scc1 L_kissue
  s_cmp_eq_u32 s3, 1
  s_cbranch_scc0 L_w23
  s_mul_i32 s92, s64, 163840
  s_mul_i32 s93, s67, 160
  s_add_u32 s92, s92, s93
  s_sub_u32 s93, 5242880, s92
  s_add_u32 s40, s12, s92
  s_addc_u32 s41, s13, 0
  s_mov_b32 s42, s93
  s_mov_b32 s43, 0x00020000
  s_mov_b32 s95, 6554
  v_add_u32 v16, 0, v1
  v_mul_lo_u32 v17, v16, s95
  v_lshrrev_b32 v17, 16, v17
  v_mul_u32_u24 v18, 10, v17
  v_sub_u32 v18, v16, v18
  v_mul_u32_u24 v17, 1280, v17
  v_lshl_add_u32 v17, v18, 4, v17
  s_mov_b32 m0, 18432
  s_nop 0
  buffer_load_dwordx4 v17, s[40:43], 0 offen nt lds
  s_waitcnt vmcnt(4)
  v_add_u32 v16, 64, v1
  v_mul_lo_u32 v17, v16, s95
  v_lshrrev_b32 v17, 16, v17
  v_mul_u32_u24 v18, 10, v17
  v_sub_u32 v18, v16, v18
  v_mul_u32_u24 v17, 1280, v17
  v_lshl_add_u32 v17, v18, 4, v17
  s_mov_b32 m0, 19456
  s_nop 0
  buffer_load_dwordx4 v17, s[40:43], 0 offen nt lds
  s_waitcnt vmcnt(4)
  v_add_u32 v16, 128, v1
  v_mul_lo_u32 v17, v16, s95
  v_lshrrev_b32 v17, 16, v17
  v_mul_u32_u24 v18, 10, v17
  v_sub_u32 v18, v16, v18
  v_mul_u32_u24 v17, 1280, v17
  v_lshl_add_u32 v17, v18, 4, v17
  s_mov_b32 m0, 20480
  s_nop 0
  buffer_load_dwordx4 v17, s[40:43], 0 offen nt lds
  s_waitcnt vmcnt(4)
  v_add_u32 v16, 192, v1
  v_mul_lo_u32 v17, v16, s95
  v_lshrrev_b32 v17, 16, v17
  v_mul_u32_u24 v18, 10, v17
  v_sub_u32 v18, v16, v18
  v_mul_u32_u24 v17, 1280, v17
  v_lshl_add_u32 v17, v18, 4, v17
  s_mov_b32 m0, 21504
  s_nop 0
  buffer_load_dwordx4 v17, s[40:43], 0 offen nt lds
  s_waitcnt vmcnt(4)
  v_add_u32 v16, 256, v1
  v_mul_lo_u32 v17, v16, s95
  v_lshrrev_b32 v17, 16, v17
  v_mul_u32_u24 v18, 10, v17
  v_sub_u32 v18, v16, v18
  v_mul_u32_u24 v17, 1280, v17
  v_lshl_add_u32 v17, v18, 4, v17
  s_mov_b32 m0, 22528
  s_nop 0
  buffer_load_dwordx4 v17, s[40:43], 0 offen nt lds
  s_waitcnt vmcnt(4)
  v_add_u32 v16, 320, v1
  v_mul_lo_u32 v17, v16, s95
  v_lshrrev_b32 v17, 16, v17
  v_mul_u32_u24 v18, 10, v17
  v_sub_u32 v18, v16, v18
  v_mul_u32_u24 v17, 1280, v17
  v_lshl_add_u32 v17, v18, 4, v17
  s_mov_b32 m0, 23552
  s_nop 0
  buffer_load_dwordx4 v17, s[40:43], 0 offen nt lds
  s_waitcnt vmcnt(4)
  v_add_u32 v16, 384, v1
  v_mul_lo_u32 v17, v16, s95
  v_lshrrev_b32 v17, 16, v17
  v_mul_u32_u24 v18, 10, v17
  v_sub_u32 v18, v16, v18
  v_mul_u32_u24 v17, 1280, v17
  v_lshl_add_u32 v17, v18, 4, v17
  s_mov_b32 m0, 24576
  s_nop 0
  buffer_load_dwordx4 v17, s[40:43], 0 offen nt lds
  s_waitcnt vmcnt(4)
  v_add_u32 v16, 448, v1
  v_mul_lo_u32 v17, v16, s95
  v_lshrrev_b32 v17, 16, v17
  v_mul_u32_u24 v18, 10, v17
  v_sub_u32 v18, v16, v18
  v_mul_u32_u24 v17, 1280, v17
  v_lshl_add_u32 v17, v18, 4, v17
  s_mov_b32 m0, 25600
  s_nop 0
  buffer_load_dwordx4 v17, s[40:43], 0 offen nt lds
  s_waitcnt vmcnt(4)
  v_add_u32 v16, 512, v1
  v_mul_lo_u32 v17, v16, s95
  v_lshrrev_b32 v17, 16, v17
  v_mul_u32_u24 v18, 10, v17
  v_sub_u32 v18, v16, v18
  v_mul_u32_u24 v17, 1280, v17
  v_lshl_add_u32 v17, v18, 4, v17
  s_mov_b32 m0, 26624
  s_nop 0
  buffer_load_dwordx4 v17, s[40:43], 0 offen nt lds
  s_waitcnt vmcnt(4)
  v_add_u32 v16, 576, v1
  v_mul_lo_u32 v17, v16, s95
  v_lshrrev_b32 v17, 16, v17
  v_mul_u32_u24 v18, 10, v17
  v_sub_u32 v18, v16, v18
  v_mul_u32_u24 v17, 1280, v17
  v_lshl_add_u32 v17, v18, 4, v17
  s_mov_b32 m0, 27648
  s_nop 0
  buffer_load_dwordx4 v17, s[40:43], 0 offen nt lds
  s_waitcnt vmcnt(4)
  v_add_u32 v16, 640, v1
  v_mul_lo_u32 v17, v16, s95
  v_lshrrev_b32 v17, 16, v17
  v_mul_u32_u24 v18, 10, v17
  v_sub_u32 v18, v16, v18
  v_mul_u32_u24 v17, 1280, v17
  v_lshl_add_u32 v17, v18, 4, v17
  s_mov_b32 m0, 28672
  s_nop 0
  buffer_load_dwordx4 v17, s[40:43], 0 offen nt lds
  s_waitcnt vmcnt(4)
  v_add_u32 v16, 704, v1
  v_mul_lo_u32 v17, v16, s95
  v_lshrrev_b32 v17, 16, v17
  v_mul_u32_u24 v18, 10, v17
  v_sub_u32 v18, v16, v18
  v_mul_u32_u24 v17, 1280, v17
  v_lshl_add_u32 v17, v18, 4, v17
  s_mov_b32 m0, 29696
  s_nop 0
  buffer_load_dwordx4 v17, s[40:43], 0 offen nt lds
  s_waitcnt vmcnt(4)
  v_add_u32 v16, 768, v1
  v_mul_lo_u32 v17, v16, s95
  v_lshrrev_b32 v17, 16, v17
  v_mul_u32_u24 v18, 10, v17
  v_sub_u32 v18, v16, v18
  v_mul_u32_u24 v17, 1280, v17
  v_lshl_add_u32 v17, v18, 4, v17
  s_mov_b32 m0, 30720
  s_nop 0
  buffer_load_dwordx4 v17, s[40:43], 0 offen nt lds
  s_waitcnt vmcnt(4)
  v_add_u32 v16, 832, v1
  v_mul_lo_u32 v17, v16, s95
  v_lshrrev_b32 v17, 16, v17
  v_mul_u32_u24 v18, 10, v17
  v_sub_u32 v18, v16, v18
  v_mul_u32_u24 v17, 1280, v17
  v_lshl_add_u32 v17, v18, 4, v17
  s_mov_b32 m0, 31744
  s_nop 0
  buffer_load_dwordx4 v17, s[40:43], 0 offen nt lds
  s_waitcnt vmcnt(4)
  v_add_u32 v16, 896, v1
  v_mul_lo_u32 v17, v16, s95
  v_lshrrev_b32 v17, 16, v17
  v_mul_u32_u24 v18, 10, v17
  v_sub_u32 v18, v16, v18
  v_mul_u32_u24 v17, 1280, v17
  v_lshl_add_u32 v17, v18, 4, v17
  s_mov_b32 m0, 32768
  s_nop 0
  buffer_load_dwordx4 v17, s[40:43], 0 offen nt lds
  s_waitcnt vmcnt(4)
  v_add_u32 v16, 960, v1
  v_mul_lo_u32 v17, v16, s95
  v_lshrrev_b32 v17, 16, v17
  v_mul_u32_u24 v18, 10, v17
  v_sub_u32 v18, v16, v18
  v_mul_u32_u24 v17, 1280, v17
  v_lshl_add_u32 v17, v18, 4, v17
  s_mov_b32 m0, 33792
  s_nop 0
  buffer_load_dwordx4 v17, s[40:43], 0 offen nt lds
  s_waitcnt vmcnt(4)
  v_add_u32 v16, 1024, v1
  v_mul_lo_u32 v17, v16, s95
  v_lshrrev_b32 v17, 16, v17
  v_mul_u32_u24 v18, 10, v17
  v_sub_u32 v18, v16, v18
  v_mul_u32_u24 v17, 1280, v17
  v_lshl_add_u32 v17, v18, 4, v17
  s_mov_b32 m0, 34816
  s_nop 0
  buffer_load_dwordx4 v17, s[40:43], 0 offen nt lds
  s_waitcnt vmcnt(4)
  v_add_u32 v16, 1088, v1
  v_mul_lo_u32 v17, v16, s95
  v_lshrrev_b32 v17, 16, v17
  v_mul_u32_u24 v18, 10, v17
  v_sub_u32 v18, v16, v18
  v_mul_u32_u24 v17, 1280, v17
  v_lshl_add_u32 v17, v18, 4, v17
  s_mov_b32 m0, 35840
  s_nop 0
  buffer_load_dwordx4 v17, s[40:43], 0 offen nt lds
  s_waitcnt vmcnt(4)
  v_add_u32 v16, 1152, v1
  v_mul_lo_u32 v17, v16, s95
  v_lshrrev_b32 v17, 16, v17
  v_mul_u32_u24 v18, 10, v17
  v_sub_u32 v18, v16, v18
  v_mul_u32_u24 v17, 1280, v17
  v_lshl_add_u32 v17, v18, 4, v17
  s_mov_b32 m0, 36864
  s_nop 0
  buffer_load_dwordx4 v17, s[40:43], 0 offen nt lds
  s_waitcnt vmcnt(4)
  v_add_u32 v16, 1216, v1
  v_mul_lo_u32 v17, v16, s95
  v_lshrrev_b32 v17, 16, v17
  v_mul_u32_u24 v18, 10, v17
  v_sub_u32 v18, v16, v18
  v_mul_u32_u24 v17, 1280, v17
  v_lshl_add_u32 v17, v18, 4, v17
  s_mov_b32 m0, 37888
  s_nop 0
  buffer_load_dwordx4 v17, s[40:43], 0 offen nt lds
  s_waitcnt vmcnt(4)
  s_branch L_kissue
L_w23:
  s_cmp_eq_u32 s77, 0
  s_cbranch_scc1 L_kissue
  s_cmp_eq_u32 s3, 3
  s_cbranch_scc1 L_w3
  s_mul_i32 s92, s67, 276480
  s_lshl_b32 s93, s64, 7
  s_add_u32 s92, s92, s93
  s_sub_u32 s93, 2211840, s92
  s_add_u32 s40, s16, s92
  s_addc_u32 s41, s17, 0
  s_mov_b32 s42, s93
  s_mov_b32 s43, 0x00020000
  s_add_u32 s44, s18, s92
  s_addc_u32 s45, s19, 0
  s_mov_b32 s46, s93
  s_mov_b32 s47, 0x00020000
  v_lshrrev_b32 v16, 3, v1
  v_and_b32 v17, 7, v1
  v_xor_b32 v17, v17, v16
  v_mul_u32_u24 v16, 3456, v16
  v_lshl_add_u32 v16, v17, 4, v16
  s_mov_b32 s93, 0
  s_mov_b32 m0, 38912
  s_nop 0
  buffer_load_dwordx4 v16, s[40:43], s93 offen nt lds
  s_waitcnt vmcnt(4)
  s_mov_b32 m0, 49152
  s_nop 0
  buffer_load_dwordx4 v16, s[44:47], s93 offen nt lds
  s_waitcnt vmcnt(4)
  s_add_u32 s93, s93, 27648
  s_mov_b32 m0, 39936
  s_nop 0
  buffer_load_dwordx4 v16, s[40:43], s93 offen nt lds
  s_waitcnt vmcnt(4)
  s_mov_b32 m0, 50176
  s_nop 0
  buffer_load_dwordx4 v16, s[44:47], s93 offen nt lds
  s_waitcnt vmcnt(4)
  s_add_u32 s93, s93, 27648
  s_mov_b32 m0, 40960
  s_nop 0
  buffer_load_dwordx4 v16, s[40:43], s93 offen nt lds
  s_waitcnt vmcnt(4)
  s_mov_b32 m0, 51200
  s_nop 0
  buffer_load_dwordx4 v16, s[44:47], s93 offen nt lds
  s_waitcnt vmcnt(4)
  s_add_u32 s93, s93, 27648
  s_mov_b32 m0, 41984
  s_nop 0
  buffer_load_dwordx4 v16, s[40:43], s93 offen nt lds
  s_waitcnt vmcnt(4)
  s_mov_b32 m0, 52224
  s_nop 0
  buffer_load_dwordx4 v16, s[44:47], s93 offen nt lds
  s_waitcnt vmcnt(4)
  s_add_u32 s93, s93, 27648
  s_mov_b32 m0, 43008
  s_nop 0
  buffer_load_dwordx4 v16, s[40:43], s93 offen nt lds
  s_waitcnt vmcnt(4)
  s_mov_b32 m0, 53248
  s_nop 0
  buffer_load_dwordx4 v16, s[44:47], s93 offen nt lds
  s_waitcnt vmcnt(4)
  s_add_u32 s93, s93, 27648
  s_mov_b32 m0, 44032
  s_nop 0
  buffer_load_dwordx4 v16, s[40:43], s93 offen nt lds
  s_waitcnt vmcnt(4)
  s_mov_b32 m0, 54272
  s_nop 0
  buffer_load_dwordx4 v16, s[44:47], s93 offen nt lds
  s_waitcnt vmcnt(4)
  s_add_u32 s93, s93, 27648
  s_mov_b32 m0, 45056
  s_nop 0
  buffer_load_dwordx4 v16, s[40:43], s93 offen nt lds
  s_waitcnt vmcnt(4)
  s_mov_b32 m0, 55296
  s_nop 0
  buffer_load_dwordx4 v16, s[44:47], s93 offen nt lds
  s_waitcnt vmcnt(4)
  s_add_u32 s93, s93, 27648
  s_mov_b32 m0, 46080
  s_nop 0
  buffer_load_dwordx4 v16, s[40:43], s93 offen nt lds
  s_waitcnt vmcnt(4)
  s_mov_b32 m0, 56320
  s_nop 0
  buffer_load_dwordx4 v16, s[44:47], s93 offen nt lds
  s_waitcnt vmcnt(4)
  s_add_u32 s93, s93, 27648
  s_mov_b32 m0, 47104
  s_nop 0
  buffer_load_dwordx4 v16, s[40:43], s93 offen nt lds
  s_waitcnt vmcnt(4)
  s_mov_b32 m0, 57344
  s_nop 0
  buffer_load_dwordx4 v16, s[44:47], s93 offen nt lds
  s_waitcnt vmcnt(4)
  s_add_u32 s93, s93, 27648
  s_mov_b32 m0, 48128
  s_nop 0
  buffer_load_dwordx4 v16, s[40:43], s93 offen nt lds
  s_waitcnt vmcnt(4)
  s_mov_b32 m0, 58368
  s_nop 0
  buffer_load_dwordx4 v16, s[44:47], s93 offen nt lds
  s_waitcnt vmcnt(4)
  s_branch L_kissue
L_w3:
  s_mul_i32 s92, s64, 81920
  s_mul_i32 s93, s67, 160
  s_add_u32 s92, s92, s93
  s_sub_u32 s93, 2211840, s92
  s_add_u32 s40, s20, s92
  s_addc_u32 s41, s21, 0
  s_mov_b32 s42, s93
  s_mov_b32 s43, 0x00020000
  s_mov_b32 s95, 6554
  v_add_u32 v16, 0, v1
  v_mul_lo_u32 v17, v16, s95
  v_lshrrev_b32 v17, 16, v17
  v_mul_u32_u24 v18, 10, v17
  v_sub_u32 v18, v16, v18
  v_mul_u32_u24 v17, 1280, v17
  v_lshl_add_u32 v17, v18, 4, v17
  s_mov_b32 m0, 59392
  s_nop 0
  buffer_load_dwordx4 v17, s[40:43], 0 offen nt lds
  s_waitcnt vmcnt(4)
  v_add_u32 v16, 64, v1
  v_mul_lo_u32 v17, v16, s95
  v_lshrrev_b32 v17, 16, v17
  v_mul_u32_u24 v18, 10, v17
  v_sub_u32 v18, v16, v18
  v_mul_u32_u24 v17, 1280, v17
  v_lshl_add_u32 v17, v18, 4, v17
  s_mov_b32 m0, 60416
  s_nop 0
  buffer_load_dwordx4 v17, s[40:43], 0 offen nt lds
  s_waitcnt vmcnt(4)
  v_add_u32 v16, 128, v1
  v_mul_lo_u32 v17, v16, s95
  v_lshrrev_b32 v17, 16, v17
  v_mul_u32_u24 v18, 10, v17
  v_sub_u32 v18, v16, v18
  v_mul_u32_u24 v17, 1280, v17
  v_lshl_add_u32 v17, v18, 4, v17
  s_mov_b32 m0, 61440
  s_nop 0
  buffer_load_dwordx4 v17, s[40:43], 0 offen nt lds
  s_waitcnt vmcnt(4)
  v_add_u32 v16, 192, v1
  v_mul_lo_u32 v17, v16, s95
  v_lshrrev_b32 v17, 16, v17
  v_mul_u32_u24 v18, 10, v17
  v_sub_u32 v18, v16, v18
  v_mul_u32_u24 v17, 1280, v17
  v_lshl_add_u32 v17, v18, 4, v17
  s_mov_b32 m0, 62464
  s_nop 0
  buffer_load_dwordx4 v17, s[40:43], 0 offen nt lds
  s_waitcnt vmcnt(4)
  v_add_u32 v16, 256, v1
  v_mul_lo_u32 v17, v16, s95
  v_lshrrev_b32 v17, 16, v17
  v_mul_u32_u24 v18, 10, v17
  v_sub_u32 v18, v16, v18
  v_mul_u32_u24 v17, 1280, v17
  v_lshl_add_u32 v17, v18, 4, v17
  s_mov_b32 m0, 63488
  s_nop 0
  buffer_load_dwordx4 v17, s[40:43], 0 offen nt lds
  s_waitcnt vmcnt(4)
  v_add_u32 v16, 320, v1
  v_mul_lo_u32 v17, v16, s95
  v_lshrrev_b32 v17, 16, v17
  v_mul_u32_u24 v18, 10, v17
  v_sub_u32 v18, v16, v18
  v_mul_u32_u24 v17, 1280, v17
  v_lshl_add_u32 v17, v18, 4, v17
  s_mov_b32 m0, 64512
  s_nop 0
  buffer_load_dwordx4 v17, s[40:43], 0 offen nt lds
  s_waitcnt vmcnt(4)
  v_add_u32 v16, 384, v1
  v_mul_lo_u32 v17, v16, s95
  v_lshrrev_b32 v17, 16, v17
  v_mul_u32_u24 v18, 10, v17
  v_sub_u32 v18, v16, v18
  v_mul_u32_u24 v17, 1280, v17
  v_lshl_add_u32 v17, v18, 4, v17
  s_mov_b32 m0, 65536
  s_nop 0
  buffer_load_dwordx4 v17, s[40:43], 0 offen nt lds
  s_waitcnt vmcnt(4)
  v_add_u32 v16, 448, v1
  v_mul_lo_u32 v17, v16, s95
  v_lshrrev_b32 v17, 16, v17
  v_mul_u32_u24 v18, 10, v17
  v_sub_u32 v18, v16, v18
  v_mul_u32_u24 v17, 1280, v17
  v_lshl_add_u32 v17, v18, 4, v17
  s_mov_b32 m0, 66560
  s_nop 0
  buffer_load_dwordx4 v17, s[40:43], 0 offen nt lds
  s_waitcnt vmcnt(4)
  v_add_u32 v16, 512, v1
  v_mul_lo_u32 v17, v16, s95
  v_lshrrev_b32 v17, 16, v17
  v_mul_u32_u24 v18, 10, v17
  v_sub_u32 v18, v16, v18
  v_mul_u32_u24 v17, 1280, v17
  v_lshl_add_u32 v17, v18, 4, v17
  s_mov_b32 m0, 67584
  s_nop 0
  buffer_load_dwordx4 v17, s[40:43], 0 offen nt lds
  s_waitcnt vmcnt(4)
  v_add_u32 v16, 576, v1
  v_mul_lo_u32 v17, v16, s95
  v_lshrrev_b32 v17, 16, v17
  v_mul_u32_u24 v18, 10, v17
  v_sub_u32 v18, v16, v18
  v_mul_u32_u24 v17, 1280, v17
  v_lshl_add_u32 v17, v18, 4, v17
  s_mov_b32 m0, 68608
  s_nop 0
  buffer_load_dwordx4 v17, s[40:43], 0 offen nt lds
  s_waitcnt vmcnt(4)
  s_branch L_kissue
L_w0:
  v_mov_b32 v20, -1
  v_mov_b32 v21, -1
  v_mov_b32 v22, -1
  v_mov_b32 v23, -1
  s_lshl_b32 s92, s68, 10
  v_add_u32 v17, s92, v2
  global_store_dwordx4 v17, v[20:23], s[26:27]
  v_add_u32 v245, 4194304, v17
  global_store_dwordx4 v245, v[20:23], s[26:27] sc1
  v_add_u32 v17, 262144, v17
  v_add_u32 v19, 4194304, v17
  s_mul_i32 s92, s67, 20480
  s_mul_i32 s93, s64, 640
  s_add_u32 s92, s92, s93
  s_add_u32 s92, s92, 524288
  v_add_u32 v18, s92, v2
  s_mov_b32 exec_hi, 1
  global_store_dwordx4 v17, v[20:23], s[26:27]
  global_store_dwordx4 v19, v[20:23], s[26:27] sc1
  s_mov_b32 exec_hi, 0xff
  global_store_dwordx4 v18, v[20:23], s[26:27] sc1
  s_mov_b64 exec, -1
  s_cmp_eq_u32 s77, 0
  s_cbranch_scc1 L_noGi
  s_mul_i32 s92, s68, 2304
  s_add_u32 s92, s92, 786432
  v_add_u32 v17, s92, v2
  v_add_u32 v24, 4194304, v17
  v_lshrrev_b32 v18, 3, v1
  v_mul_u32_u24 v18, 3456, v18
  v_and_b32 v19, 7, v1
  v_lshl_add_u32 v18, v19, 4, v18
  s_mul_i32 s92, s67, 17280
  s_lshl_b32 s93, s64, 7
  s_add_u32 s92, s92, s93
  s_add_u32 s92, s92, 1310720
  v_add_u32 v18, s92, v18
  global_store_dwordx4 v17, v[20:23], s[26:27]
  global_store_dwordx4 v17, v[20:23], s[26:27] offset:1024
  global_store_dwordx4 v24, v[20:23], s[26:27] sc1
  global_store_dwordx4 v24, v[20:23], s[26:27] offset:1024 sc1
  s_mov_b32 exec_hi, 0xff
  global_store_dwordx4 v18, v[20:23], s[26:27] sc1
  s_mov_b64 exec, 1
  global_store_dwordx4 v17, v[20:23], s[26:27] offset:2048
  global_store_dwordx4 v24, v[20:23], s[26:27] offset:2048 sc1
  s_mov_b64 exec, -1
L_noGi:
  v_lshrrev_b32 v16, 5, v1
  v_mul_u32_u24 v16, 1280, v16
  v_and_b32 v17, 31, v1
  v_lshl_add_u32 v16, v17, 3, v16
  global_load_dwordx2 v[46:47], v16, s[4:5] offset:0
  global_load_dwordx2 v[48:49], v16, s[4:5] offset:256
  global_load_dwordx2 v[50:51], v16, s[4:5] offset:512
  global_load_dwordx2 v[52:53], v16, s[4:5] offset:768
  global_load_dwordx2 v[54:55], v16, s[4:5] offset:1024
  v_lshl_add_u32 v17, v3, 2, v4
  s_mul_i32 s92, s67, 80
  v_add_u32 v17, s92, v17
  v_min_u32 v18, 575, v17
  v_lshlrev_b32 v17, 1, v17
  v_lshlrev_b32 v18, 1, v18
  global_load_ushort v56, v17, s[4:5]
  global_load_ushort v57, v17, s[4:5] offset:1280
  global_load_ushort v58, v18, s[4:5] offset:128
  global_load_ushort v59, v18, s[4:5] offset:1408
  s_mul_i32 s92, s67, 655360
  s_lshl_b32 s93, s64, 8
  s_add_u32 s92, s92, s93
  s_sub_u32 s94, 5242880, s92
  s_add_u32 s36, s10, s92
  s_addc_u32 s37, s11, 0
  s_mov_b32 s38, s94
  s_mov_b32 s39, 0x00020000
  v_lshlrev_b32 v16, 4, v3
  v_lshl_add_u32 v16, v4, 13, v16
  buffer_load_dwordx4 v[100:103], v16, s[36:39], s71 offen nt
  s_add_u32 s71, s71, 32768
  buffer_load_dwordx4 v[104:107], v16, s[36:39], s71 offen nt
  s_add_u32 s71, s71, 32768
  buffer_load_dwordx4 v[108:111], v16, s[36:39], s71 offen nt
  s_add_u32 s71, s71, 32768
  buffer_load_dwordx4 v[112:115], v16, s[36:39], s71 offen nt
  s_add_u32 s71, s71, 32768
  buffer_load_dwordx4 v[116:119], v16, s[36:39], s71 offen nt
  s_add_u32 s71, s71, 32768
  buffer_load_dwordx4 v[120:123], v16, s[36:39], s71 offen nt
  s_add_u32 s71, s71, 32768
  buffer_load_dwordx4 v[124:127], v16, s[36:39], s71 offen nt
  s_add_u32 s71, s71, 32768
  buffer_load_dwordx4 v[128:131], v16, s[36:39], s71 offen nt
  s_add_u32 s71, s71, 32768
  buffer_load_dwordx4 v[132:135], v16, s[36:39], s71 offen nt
  s_add_u32 s71, s71, 32768
  buffer_load_dwordx4 v[136:139], v16, s[36:39], s71 offen nt
  s_add_u32 s71, s71, 32768
  buffer_load_dwordx4 v[140:143], v16, s[36:39], s71 offen nt
  s_add_u32 s71, s71, 32768
  buffer_load_dwordx4 v[144:147], v16, s[36:39], s71 offen nt
  s_add_u32 s71, s71, 32768
  buffer_load_dwordx4 v[148:151], v16, s[36:39], s71 offen nt
  s_add_u32 s71, s71, 32768
  buffer_load_dwordx4 v[152:155], v16, s[36:39], s71 offen nt
  s_add_u32 s71, s71, 32768
  buffer_load_dwordx4 v[156:159], v16, s[36:39], s71 offen nt
  s_add_u32 s71, s71, 32768
  buffer_load_dwordx4 v[160:163], v16, s[36:39], s71 offen nt
  s_add_u32 s71, s71, 32768
  buffer_load_dwordx4 v[164:167], v16, s[36:39], s71 offen nt
  s_add_u32 s71, s71, 32768
  buffer_load_dwordx4 v[168:171], v16, s[36:39], s71 offen nt
  s_add_u32 s71, s71, 32768
  buffer_load_dwordx4 v[172:175], v16, s[36:39], s71 offen nt
  s_add_u32 s71, s71, 32768
  buffer_load_dwordx4 v[176:179], v16, s[36:39], s71 offen nt
  s_barrier
  v_and_b32 v16, 8, v3
  v_cmp_ne_u32 vcc, 0, v16
  v_mov_b32 v17, 0x0100
  v_mov_b32 v18, 0x0302
  v_cndmask_b32 v17, v17, v18, vcc
  v_lshlrev_b32 v18, 16, v17
  v_or_b32 v18, 0x0c0c, v18
  v_or_b32 v17, 0x0c0c0000, v17
  v_and_b32 v16, 1, v3
  v_cmp_ne_u32 vcc, 0, v16
  s_nop 1
  v_cndmask_b32 v17, v17, v18, vcc
  v_bfe_u32 v16, v3, 1, 2
  v_mov_b32 v18, 0x0c0c0c0c
  v_cmp_eq_u32 vcc, 0, v16
  s_nop 1
  v_cndmask_b32 v5, v18, v17, vcc
  v_cmp_eq_u32 vcc, 1, v16
  s_nop 1
  v_cndmask_b32 v6, v18, v17, vcc
  v_cmp_eq_u32 vcc, 2, v16
  s_nop 1
  v_cndmask_b32 v7, v18, v17, vcc
  v_cmp_eq_u32 vcc, 3, v16
  s_nop 1
  v_cndmask_b32 v8, v18, v17, vcc
  v_mov_b32 v16, 0x3f803f80
  v_lshlrev_b32 v17, 2, v1
  ds_write_b32 v17, v16 offset:17920
  v_mov_b32 v17, s68
  s_or_b32 s92, s79, 0x10
  v_mov_b32 v18, s92
  s_waitcnt vmcnt(20)
  s_mov_b64 exec, 1
  global_store_byte v17, v18, s[24:25] sc1
  s_mov_b64 exec, -1
  v_lshlrev_b32 v24, 16, v46
  v_lshlrev_b32 v26, 16, v47
  v_lshlrev_b32 v28, 16, v48
  v_lshlrev_b32 v30, 16, v49
  v_lshlrev_b32 v32, 16, v50
  v_lshlrev_b32 v34, 16, v51
  v_lshlrev_b32 v36, 16, v52
  v_lshlrev_b32 v38, 16, v53
  v_lshlrev_b32 v40, 16, v54
  v_lshlrev_b32 v42, 16, v55
  v_and_b32 v25, 0xffff0000, v46
  v_and_b32 v27, 0xffff0000, v47
  v_and_b32 v29, 0xffff0000, v48
  v_and_b32 v31, 0xffff0000, v49
  v_and_b32 v33, 0xffff0000, v50
  v_and_b32 v35, 0xffff0000, v51
  v_and_b32 v37, 0xffff0000, v52
  v_and_b32 v39, 0xffff0000, v53
  v_and_b32 v41, 0xffff0000, v54
  v_and_b32 v43, 0xffff0000, v55
  v_add_f32 v16, v24, v26
  v_add_f32 v18, v28, v30
  v_add_f32 v16, v16, v32
  v_add_f32 v18, v18, v34
  v_add_f32 v16, v16, v36
  v_add_f32 v18, v18, v38
  v_add_f32 v16, v16, v40
  v_add_f32 v18, v18, v42
  v_add_f32 v16, v16, v25
  v_add_f32 v18, v18, v27
  v_add_f32 v16, v16, v29
  v_add_f32 v18, v18, v31
  v_add_f32 v16, v16, v33
  v_add_f32 v18, v18, v35
  v_add_f32 v16, v16, v37
  v_add_f32 v18, v18, v39
  v_add_f32 v16, v16, v41
  v_add_f32 v18, v18, v43
  v_add_f32 v16, v16, v18
  s_nop 1
  v_add_f32_dpp v18, v16, v16 quad_perm:[1,0,3,2] row_mask:0xf bank_mask:0xf
  s_nop 1
  v_add_f32_dpp v16, v18, v18 quad_perm:[2,3,0,1] row_mask:0xf bank_mask:0xf
  s_nop 1
  v_add_f32_dpp v18, v16, v16 row_half_mirror row_mask:0xf bank_mask:0xf
  s_nop 1
  v_add_f32_dpp v16, v18, v18 row_mirror row_mask:0xf bank_mask:0xf
  v_mov_b32 v18, v16
  s_nop 1
  v_permlane16_swap_b32 v16, v18
  v_add_f32 v16, v16, v18
  v_mul_f32 v16, 0x3acccccd, v16
  v_sub_f32 v24, v24, v16
  v_sub_f32 v26, v26, v16
  v_sub_f32 v28, v28, v16
  v_sub_f32 v30, v30, v16
  v_sub_f32 v32, v32, v16
  v_sub_f32 v34, v34, v16
  v_sub_f32 v36, v36, v16
  v_sub_f32 v38, v38, v16
  v_sub_f32 v40, v40, v16
  v_sub_f32 v42, v42, v16
  v_sub_f32 v25, v25, v16
  v_sub_f32 v27, v27, v16
  v_sub_f32 v29, v29, v16
  v_sub_f32 v31, v31, v16
  v_sub_f32 v33, v33, v16
  v_sub_f32 v35, v35, v16
  v_sub_f32 v37, v37, v16
  v_sub_f32 v39, v39, v16
  v_sub_f32 v41, v41, v16
  v_sub_f32 v43, v43, v16
  v_mul_f32 v17, v24, v24
  v_mul_f32 v19, v26, v26
  v_fmac_f32 v17, v28, v28
  v_fmac_f32 v19, v30, v30
  v_fmac_f32 v17, v32, v32
  v_fmac_f32 v19, v34, v34
  v_fmac_f32 v17, v36, v36
  v_fmac_f32 v19, v38, v38
  v_fmac_f32 v17, v40, v40
  v_fmac_f32 v19, v42, v42
  v_fmac_f32 v17, v25, v25
  v_fmac_f32 v19, v27, v27
  v_fmac_f32 v17, v29, v29
  v_fmac_f32 v19, v31, v31
  v_fmac_f32 v17, v33, v33
  v_fmac_f32 v19, v35, v35
  v_fmac_f32 v17, v37, v37
  v_fmac_f32 v19, v39, v39
  v_fmac_f32 v17, v41, v41
  v_fmac_f32 v19, v43, v43
  v_add_f32 v17, v17, v19
  s_nop 1
  v_add_f32_dpp v18, v17, v17 quad_perm:[1,0,3,2] row_mask:0xf bank_mask:0xf
  s_nop 1
  v_add_f32_dpp v17, v18, v18 quad_perm:[2,3,0,1] row_mask:0xf bank_mask:0xf
  s_nop 1
  v_add_f32_dpp v18, v17, v17 row_half_mirror row_mask:0xf bank_mask:0xf
  s_nop 1
  v_add_f32_dpp v17, v18, v18 row_mirror row_mask:0xf bank_mask:0xf
  v_mov_b32 v18, v17
  s_nop 1
  v_permlane16_swap_b32 v17, v18
  v_add_f32 v17, v17, v18
  v_mul_f32 v17, 0x3acccccd, v17
  v_cvt_pk_bf16_f32 v20, v16, v16
  v_lshlrev_b32 v20, 16, v20
  v_cvt_pk_bf16_f32 v23, v17, v17
  v_lshlrev_b32 v23, 16, v23
  v_add_f32 v23, 0x3727c5ac, v23
  v_cvt_pk_bf16_f32 v23, v23, v23
  v_lshlrev_b32 v23, 16, v23
  v_sqrt_f32 v23, v23
  s_nop 0
  v_cvt_pk_bf16_f32 v21, v23, v23
  v_lshlrev_b32 v21, 16, v21
  v_rcp_f32 v22, v21
  v_readlane_b32 s48, v20, 0
  v_readlane_b32 s51, v20, 32
  v_readlane_b32 s49, v21, 0
  v_readlane_b32 s52, v21, 32
  v_readlane_b32 s50, v22, 0
  v_readlane_b32 s53, v22, 32
  v_mov_b32 v24, s48
  v_mov_b32 v25, s49
  v_mov_b32 v26, s50
  v_mov_b32 v27, s51
  v_mov_b32 v28, s52
  v_mov_b32 v29, s53
  v_lshlrev_b32 v56, 16, v56
  v_lshlrev_b32 v57, 16, v57
  v_lshlrev_b32 v58, 16, v58
  v_lshlrev_b32 v59, 16, v59
  v_sub_f32 v56, v56, v24
  v_cvt_pk_bf16_f32 v56, v56, v56
  v_lshlrev_b32 v56, 16, v56
  v_mul_f32 v30, v56, v26
  v_fma_f32 v31, -v30, v25, v56
  v_fma_f32 v56, v31, v26, v30
  v_sub_f32 v57, v57, v27
  v_cvt_pk_bf16_f32 v57, v57, v57
  v_lshlrev_b32 v57, 16, v57
  v_mul_f32 v30, v57, v29
  v_fma_f32 v31, -v30, v28, v57
  v_fma_f32 v57, v31, v29, v30
  v_sub_f32 v58, v58, v24
  v_cvt_pk_bf16_f32 v58, v58, v58
  v_lshlrev_b32 v58, 16, v58
  v_mul_f32 v30, v58, v26
  v_fma_f32 v31, -v30, v25, v58
  v_fma_f32 v58, v31, v26, v30
  v_sub_f32 v59, v59, v27
  v_cvt_pk_bf16_f32 v59, v59, v59
  v_lshlrev_b32 v59, 16, v59
  v_mul_f32 v30, v59, v29
  v_fma_f32 v31, -v30, v28, v59
  v_fma_f32 v59, v31, v29, v30
  v_cvt_pk_bf16_f32 v36, v56, v57
  v_cvt_pk_bf16_f32 v37, v58, v59
  s_nop 0
  v_mov_b32_dpp v92, v36 row_newbcast:0 row_mask:0xf bank_mask:0xf
  v_perm_b32 v84, v92, v92, v5
  v_perm_b32 v85, v92, v92, v6
  v_perm_b32 v86, v92, v92, v7
  v_perm_b32 v87, v92, v92, v8
  v_mov_b32_dpp v93, v36 row_newbcast:1 row_mask:0xf bank_mask:0xf
  v_perm_b32 v88, v93, v93, v5
  v_perm_b32 v89, v93, v93, v6
  v_perm_b32 v90, v93, v93, v7
  v_perm_b32 v91, v93, v93, v8
  s_waitcnt vmcnt(19)
  v_mfma_f32_16x16x32_bf16 v[80:83], v[84:87], v[100:103], 0
  v_mov_b32_dpp v92, v36 row_newbcast:2 row_mask:0xf bank_mask:0xf
  v_perm_b32 v84, v92, v92, v5
  v_perm_b32 v85, v92, v92, v6
  v_perm_b32 v86, v92, v92, v7
  v_perm_b32 v87, v92, v92, v8
  s_waitcnt vmcnt(18)
  v_mfma_f32_16x16x32_bf16 v[80:83], v[88:91], v[104:107], v[80:83]
  v_mov_b32_dpp v93, v36 row_newbcast:3 row_mask:0xf bank_mask:0xf
  v_perm_b32 v88, v93, v93, v5
  v_perm_b32 v89, v93, v93, v6
  v_perm_b32 v90, v93, v93, v7
  v_perm_b32 v91, v93, v93, v8
  s_waitcnt vmcnt(17)
  v_mfma_f32_16x16x32_bf16 v[80:83], v[84:87], v[108:111], v[80:83]
  v_mov_b32_dpp v92, v36 row_newbcast:4 row_mask:0xf bank_mask:0xf
  v_perm_b32 v84, v92, v92, v5
  v_perm_b32 v85, v92, v92, v6
  v_perm_b32 v86, v92, v92, v7
  v_perm_b32 v87, v92, v92, v8
  s_waitcnt vmcnt(16)
  v_mfma_f32_16x16x32_bf16 v[80:83], v[88:91], v[112:115], v[80:83]
  v_mov_b32_dpp v93, v36 row_newbcast:5 row_mask:0xf bank_mask:0xf
  v_perm_b32 v88, v93, v93, v5
  v_perm_b32 v89, v93, v93, v6
  v_perm_b32 v90, v93, v93, v7
  v_perm_b32 v91, v93, v93, v8
  s_waitcnt vmcnt(15)
  v_mfma_f32_16x16x32_bf16 v[80:83], v[84:87], v[116:119], v[80:83]
  v_mov_b32_dpp v92, v36 row_newbcast:6 row_mask:0xf bank_mask:0xf
  v_perm_b32 v84, v92, v92, v5
  v_perm_b32 v85, v92, v92, v6
  v_perm_b32 v86, v92, v92, v7
  v_perm_b32 v87, v92, v92, v8
  s_waitcnt vmcnt(14)
  v_mfma_f32_16x16x32_bf16 v[80:83], v[88:91], v[120:123], v[80:83]
  v_mov_b32_dpp v93, v36 row_newbcast:7 row_mask:0xf bank_mask:0xf
  v_perm_b32 v88, v93, v93, v5
  v_perm_b32 v89, v93, v93, v6
  v_perm_b32 v90, v93, v93, v7
  v_perm_b32 v91, v93, v93, v8
  s_waitcnt vmcnt(13)
  v_mfma_f32_16x16x32_bf16 v[80:83], v[84:87], v[124:127], v[80:83]
  v_mov_b32_dpp v92, v36 row_newbcast:8 row_mask:0xf bank_mask:0xf
  v_perm_b32 v84, v92, v92, v5
  v_perm_b32 v85, v92, v92, v6
  v_perm_b32 v86, v92, v92, v7
  v_perm_b32 v87, v92, v92, v8
  s_waitcnt vmcnt(12)
  v_mfma_f32_16x16x32_bf16 v[80:83], v[88:91], v[128:131], v[80:83]
  v_mov_b32_dpp v93, v36 row_newbcast:9 row_mask:0xf bank_mask:0xf
  v_perm_b32 v88, v93, v93, v5
  v_perm_b32 v89, v93, v93, v6
  v_perm_b32 v90, v93, v93, v7
  v_perm_b32 v91, v93, v93, v8
  s_waitcnt vmcnt(11)
  v_mfma_f32_16x16x32_bf16 v[80:83], v[84:87], v[132:135], v[80:83]
  v_mov_b32_dpp v92, v36 row_newbcast:10 row_mask:0xf bank_mask:0xf
  v_perm_b32 v84, v92, v92, v5
  v_perm_b32 v85, v92, v92, v6
  v_perm_b32 v86, v92, v92, v7
  v_perm_b32 v87, v92, v92, v8
  s_waitcnt vmcnt(10)
  v_mfma_f32_16x16x32_bf16 v[80:83], v[88:91], v[136:139], v[80:83]
  v_mov_b32_dpp v93, v36 row_newbcast:11 row_mask:0xf bank_mask:0xf
  v_perm_b32 v88, v93, v93, v5
  v_perm_b32 v89, v93, v93, v6
  v_perm_b32 v90, v93, v93, v7
  v_perm_b32 v91, v93, v93, v8
  s_waitcnt vmcnt(9)
  v_mfma_f32_16x16x32_bf16 v[80:83], v[84:87], v[140:143], v[80:83]
  v_mov_b32_dpp v92, v36 row_newbcast:12 row_mask:0xf bank_mask:0xf
  v_perm_b32 v84, v92, v92, v5
  v_perm_b32 v85, v92, v92, v6
  v_perm_b32 v86, v92, v92, v7
  v_perm_b32 v87, v92, v92, v8
  s_waitcnt vmcnt(8)
  v_mfma_f32_16x16x32_bf16 v[80:83], v[88:91], v[144:147], v[80:83]
  v_mov_b32_dpp v93, v36 row_newbcast:13 row_mask:0xf bank_mask:0xf
  v_perm_b32 v88, v93, v93, v5
  v_perm_b32 v89, v93, v93, v6
  v_perm_b32 v90, v93, v93, v7
  v_perm_b32 v91, v93, v93, v8
  s_waitcnt vmcnt(7)
  v_mfma_f32_16x16x32_bf16 v[80:83], v[84:87], v[148:151], v[80:83]
  v_mov_b32_dpp v92, v36 row_newbcast:14 row_mask:0xf bank_mask:0xf
  v_perm_b32 v84, v92, v92, v5
  v_perm_b32 v85, v92, v92, v6
  v_perm_b32 v86, v92, v92, v7
  v_perm_b32 v87, v92, v92, v8
  s_waitcnt vmcnt(6)
  v_mfma_f32_16x16x32_bf16 v[80:83], v[88:91], v[152:155], v[80:83]
  v_mov_b32_dpp v93, v36 row_newbcast:15 row_mask:0xf bank_mask:0xf
  v_perm_b32 v88, v93, v93, v5
  v_perm_b32 v89, v93, v93, v6
  v_perm_b32 v90, v93, v93, v7
  v_perm_b32 v91, v93, v93, v8
  s_waitcnt vmcnt(5)
  v_mfma_f32_16x16x32_bf16 v[80:83], v[84:87], v[156:159], v[80:83]
  v_mov_b32_dpp v92, v37 row_newbcast:0 row_mask:0xf bank_mask:0xf
  v_perm_b32 v84, v92, v92, v5
  v_perm_b32 v85, v92, v92, v6
  v_perm_b32 v86, v92, v92, v7
  v_perm_b32 v87, v92, v92, v8
  s_waitcnt vmcnt(4)
  v_mfma_f32_16x16x32_bf16 v[80:83], v[88:91], v[160:163], v[80:83]
  v_mov_b32_dpp v93, v37 row_newbcast:1 row_mask:0xf bank_mask:0xf
  v_perm_b32 v88, v93, v93, v5
  v_perm_b32 v89, v93, v93, v6
  v_perm_b32 v90, v93, v93, v7
  v_perm_b32 v91, v93, v93, v8
  s_waitcnt vmcnt(3)
  v_mfma_f32_16x16x32_bf16 v[80:83], v[84:87], v[164:167], v[80:83]
  v_mov_b32_dpp v92, v37 row_newbcast:2 row_mask:0xf bank_mask:0xf
  v_perm_b32 v84, v92, v92, v5
  v_perm_b32 v85, v92, v92, v6
  v_perm_b32 v86, v92, v92, v7
  v_perm_b32 v87, v92, v92, v8
  s_waitcnt vmcnt(2)
  v_mfma_f32_16x16x32_bf16 v[80:83], v[88:91], v[168:171], v[80:83]
  v_mov_b32_dpp v93, v37 row_newbcast:3 row_mask:0xf bank_mask:0xf
  v_perm_b32 v88, v93, v93, v5
  v_perm_b32 v89, v93, v93, v6
  v_perm_b32 v90, v93, v93, v7
  v_perm_b32 v91, v93, v93, v8
  s_waitcnt vmcnt(1)
  v_mfma_f32_16x16x32_bf16 v[80:83], v[84:87], v[172:175], v[80:83]
  s_waitcnt vmcnt(0)
  v_mfma_f32_16x16x32_bf16 v[80:83], v[88:91], v[176:179], v[80:83]
  s_lshl_b32 s92, s64, 3
  v_mov_b32 v18, s92
  global_load_dwordx2 v[38:39], v18, s[24:25] sc1
  v_and_b32 v16, 1, v4
  v_lshlrev_b32 v16, 4, v16
  v_lshl_add_u32 v16, v3, 5, v16
  v_lshrrev_b32 v17, 1, v4
  v_lshl_add_u32 v16, v17, 9, v16
  s_lshl_b32 s92, s68, 10
  v_add_u32 v16, s92, v16
  v_min_u32 v80, -2, v80
  v_min_u32 v81, -2, v81
  v_min_u32 v82, -2, v82
  v_min_u32 v83, -2, v83
  global_store_dwordx4 v16, v[80:83], s[26:27]
  v_add_u32 v245, 4194304, v16
  global_store_dwordx4 v245, v[80:83], s[26:27] sc1
  s_mov_b32 s96, 0
  s_or_b32 s92, s79, 0x10
  s_mul_i32 s94, s92, 0x01010101
  s_waitcnt vmcnt(2)
L_qf_loop:
  v_readfirstlane_b32 s92, v38
  v_readfirstlane_b32 s93, v39
  s_nop 0
  s_and_b32 s95, s92, s93
  s_and_b32 s95, s95, 0x10101010
  s_cmp_eq_u32 s95, 0x10101010
  s_cbranch_scc1 L_qf_ok
  s_add_u32 s96, s96, 1
  s_cmp_gt_u32 s96, 200000
  s_cbranch_scc1 L_qf_ok
  global_load_dwordx2 v[38:39], v18, s[24:25] sc1
  s_waitcnt vmcnt(0)
  s_branch L_qf_loop
L_qf_ok:
  s_cmp_eq_u32 s92, s94
  s_cselect_b32 s80, 0, 4194304
  s_cmp_eq_u32 s93, s94
  s_cselect_b32 s80, s80, 4194304
  s_lshl_b32 s92, s64, 13
  s_lshl_b32 s93, s65, 9
  s_add_u32 s92, s92, s93
  s_add_u32 s92, s92, s80
  v_lshlrev_b32 v16, 3, v1
  v_add_u32 v16, s92, v16
  v_add_u32 v17, 4096, v16
  s_mov_b32 s96, 0
  global_load_dwordx2 v[20:21], v16, s[26:27] offset:0 sc1
  global_load_dwordx2 v[22:23], v16, s[26:27] offset:1024 sc1
  global_load_dwordx2 v[24:25], v16, s[26:27] offset:2048 sc1
  global_load_dwordx2 v[26:27], v16, s[26:27] offset:3072 sc1
  global_load_dwordx2 v[28:29], v17, s[26:27] offset:0 sc1
  global_load_dwordx2 v[30:31], v17, s[26:27] offset:1024 sc1
  global_load_dwordx2 v[32:33], v17, s[26:27] offset:2048 sc1
  global_load_dwordx2 v[34:35], v17, s[26:27] offset:3072 sc1
L_pq_loop:
  s_waitcnt vmcnt(0)
  v_max_u32 v248, v20, v21
  v_max3_u32 v248, v248, v22, v23
  v_max3_u32 v248, v248, v24, v25
  v_max3_u32 v248, v248, v26, v27
  v_max3_u32 v248, v248, v28, v29
  v_max3_u32 v248, v248, v30, v31
  v_max3_u32 v248, v248, v32, v33
  v_max3_u32 v248, v248, v34, v35
  v_cmp_eq_u32 vcc, -1, v248
  s_nop 0
  s_cmp_eq_u64 vcc, 0
  s_cbranch_scc1 L_pq_ok
  s_add_u32 s96, s96, 1
  s_cmp_gt_u32 s96, 200000
  s_cbranch_scc1 L_pq_ok
  v_max_u32 v248, v20, v21
  v_cmp_eq_u32 vcc, -1, v248
  s_nop 0
  s_cmp_eq_u64 vcc, 0
  s_cbranch_scc1 L_pq_n0
  global_load_dwordx2 v[20:21], v16, s[26:27] offset:0 sc1
L_pq_n0:
  v_max_u32 v248, v22, v23
  v_cmp_eq_u32 vcc, -1, v248
  s_nop 0
  s_cmp_eq_u64 vcc, 0
  s_cbranch_scc1 L_pq_n1
  global_load_dwordx2 v[22:23], v16, s[26:27] offset:1024 sc1
L_pq_n1:
  v_max_u32 v248, v24, v25
  v_cmp_eq_u32 vcc, -1, v248
  s_nop 0
  s_cmp_eq_u64 vcc, 0
  s_cbranch_scc1 L_pq_n2
  global_load_dwordx2 v[24:25], v16, s[26:27] offset:2048 sc1
L_pq_n2:
  v_max_u32 v248, v26, v27
  v_cmp_eq_u32 vcc, -1, v248
  s_nop 0
  s_cmp_eq_u64 vcc, 0
  s_cbranch_scc1 L_pq_n3
  global_load_dwordx2 v[26:27], v16, s[26:27] offset:3072 sc1
L_pq_n3:
  v_max_u32 v248, v28, v29
  v_cmp_eq_u32 vcc, -1, v248
  s_nop 0
  s_cmp_eq_u64 vcc, 0
  s_cbranch_scc1 L_pq_n4
  global_load_dwordx2 v[28:29], v17, s[26:27] offset:0 sc1
L_pq_n4:
  v_max_u32 v248, v30, v31
  v_cmp_eq_u32 vcc, -1, v248
  s_nop 0
  s_cmp_eq_u64 vcc, 0
  s_cbranch_scc1 L_pq_n5
  global_load_dwordx2 v[30:31], v17, s[26:27] offset:1024 sc1
L_pq_n5:
  v_max_u32 v248, v32, v33
  v_cmp_eq_u32 vcc, -1, v248
  s_nop 0
  s_cmp_eq_u64 vcc, 0
  s_cbranch_scc1 L_pq_n6
  global_load_dwordx2 v[32:33], v17, s[26:27] offset:2048 sc1
L_pq_n6:
  v_max_u32 v248, v34, v35
  v_cmp_eq_u32 vcc, -1, v248
  s_nop 0
  s_cmp_eq_u64 vcc, 0
  s_cbranch_scc1 L_pq_n7
  global_load_dwordx2 v[34:35], v17, s[26:27] offset:3072 sc1
L_pq_n7:
  s_branch L_pq_loop
L_pq_ok:
  v_add_f32 v20, v20, v22
  v_add_f32 v21, v21, v23
  v_add_f32 v20, v20, v24
  v_add_f32 v21, v21, v25
  v_add_f32 v20, v20, v26
  v_add_f32 v21, v21, v27
  v_add_f32 v20, v20, v28
  v_add_f32 v21, v21, v29
  v_add_f32 v20, v20, v30
  v_add_f32 v21, v21, v31
  v_add_f32 v20, v20, v32
  v_add_f32 v21, v21, v33
  v_add_f32 v20, v20, v34
  v_add_f32 v21, v21, v35
  v_cvt_pk_bf16_f32 v20, v20, v21
  v_lshlrev_b32 v16, 2, v1
  ds_write_b32 v16, v20 offset:0
  v_mov_b32 v17, s80
  v_mov_b32 v18, 384
  ds_write_b32 v18, v17
  s_waitcnt lgkmcnt(0)
  s_barrier
  buffer_load_dwordx4 v[100:103], v2, s[28:31], s69 offen nt
  s_add_u32 s69, s69, 1024
  buffer_load_dwordx4 v[104:107], v2, s[28:31], s69 offen nt
  s_add_u32 s69, s69, 1024
  buffer_load_dwordx4 v[108:111], v2, s[28:31], s69 offen nt
  s_add_u32 s69, s69, 1024
  buffer_load_dwordx4 v[112:115], v2, s[28:31], s69 offen nt
  buffer_load_dwordx4 v[116:119], v2, s[32:35], s70 offen nt
  s_add_u32 s70, s70, 1024
  buffer_load_dwordx4 v[120:123], v2, s[32:35], s70 offen nt
  s_add_u32 s70, s70, 1024
  buffer_load_dwordx4 v[124:127], v2, s[32:35], s70 offen nt
  s_add_u32 s70, s70, 1024
  buffer_load_dwordx4 v[128:131], v2, s[32:35], s70 offen nt
  v_lshlrev_b32 v247, 2, v1
  global_load_dword v249, v247, s[24:25] sc1
  v_lshrrev_b32 v16, 5, v1
  v_and_b32 v17, 31, v1
  v_min_u32 v17, 19, v17
  v_bfe_u32 v18, v1, 2, 1
  v_and_b32 v19, 3, v1
  s_lshl_b32 s92, s78, 2
  v_add_u32 v19, s92, v19
  s_cmp_eq_u32 s77, 1
  s_cselect_b64 s[86:87], -1, 0
  v_cndmask_b32 v16, v18, v16, s[86:87]
  v_cndmask_b32 v17, v19, v17, s[86:87]
  v_mul_u32_u24 v16, 1280, v16
  v_lshl_add_u32 v16, v17, 3, v16
  s_mul_i32 s92, s67, 160
  v_add_u32 v16, s92, v16
  global_load_dwordx2 v[12:13], v16, s[4:5]
  v_mov_b32 v17, 0
  global_load_dword v10, v17, s[22:23]
  v_lshlrev_b32 v16, 4, v3
  ds_read_b128 v[76:79], v16 offset:0
  v_mov_b32 v17, 384
  ds_read_b32 v17, v17
  s_waitcnt lgkmcnt(0)
  v_readfirstlane_b32 s80, v17
  s_waitcnt vmcnt(10)
  v_dot2_f32_bf16 v60, v100, v76, 0
  s_nop 2
  v_dot2_f32_bf16 v60, v101, v77, v60
  s_nop 2
  v_dot2_f32_bf16 v60, v102, v78, v60
  s_nop 2
  v_dot2_f32_bf16 v60, v103, v79, v60
  s_waitcnt vmcnt(9)
  v_dot2_f32_bf16 v61, v104, v76, 0
  s_nop 2
  v_dot2_f32_bf16 v61, v105, v77, v61
  s_nop 2
  v_dot2_f32_bf16 v61, v106, v78, v61
  s_nop 2
  v_dot2_f32_bf16 v61, v107, v79, v61
  s_waitcnt vmcnt(8)
  v_dot2_f32_bf16 v62, v108, v76, 0
  s_nop 2
  v_dot2_f32_bf16 v62, v109, v77, v62
  s_nop 2
  v_dot2_f32_bf16 v62, v110, v78, v62
  s_nop 2
  v_dot2_f32_bf16 v62, v111, v79, v62
  s_waitcnt vmcnt(7)
  v_dot2_f32_bf16 v63, v112, v76, 0
  s_nop 2
  v_dot2_f32_bf16 v63, v113, v77, v63
  s_nop 2
  v_dot2_f32_bf16 v63, v114, v78, v63
  s_nop 2
  v_dot2_f32_bf16 v63, v115, v79, v63
  v_mov_b32 v64, 0
  v_mov_b32 v65, 0
  v_mov_b32 v66, 0
  v_mov_b32 v67, 0
  v_mov_b32 v68, 0
  v_mov_b32 v69, 0
  v_mov_b32 v70, 0
  v_mov_b32 v71, 0
  v_mov_b32 v72, 0
  v_mov_b32 v73, 0
  v_mov_b32 v74, 0
  v_mov_b32 v75, 0
  v_add_f32_dpp v60, v60, v60 row_ror:8 row_mask:0xf bank_mask:0x3
  v_add_f32_dpp v61, v61, v61 row_ror:8 row_mask:0xf bank_mask:0x3
  v_add_f32_dpp v62, v62, v62 row_ror:8 row_mask:0xf bank_mask:0x3
  v_add_f32_dpp v63, v63, v63 row_ror:8 row_mask:0xf bank_mask:0x3
  v_add_f32_dpp v64, v64, v64 row_ror:8 row_mask:0xf bank_mask:0x3
  v_add_f32_dpp v65, v65, v65 row_ror:8 row_mask:0xf bank_mask:0x3
  v_add_f32_dpp v66, v66, v66 row_ror:8 row_mask:0xf bank_mask:0x3
  v_add_f32_dpp v67, v67, v67 row_ror:8 row_mask:0xf bank_mask:0x3
  v_add_f32_dpp v60, v68, v68 row_ror:8 row_mask:0xf bank_mask:0xc
  v_add_f32_dpp v61, v69, v69 row_ror:8 row_mask:0xf bank_mask:0xc
  v_add_f32_dpp v62, v70, v70 row_ror:8 row_mask:0xf bank_mask:0xc
  v_add_f32_dpp v63, v71, v71 row_ror:8 row_mask:0xf bank_mask:0xc
  v_add_f32_dpp v64, v72, v72 row_ror:8 row_mask:0xf bank_mask:0xc
  v_add_f32_dpp v65, v73, v73 row_ror:8 row_mask:0xf bank_mask:0xc
  v_add_f32_dpp v66, v74, v74 row_ror:8 row_mask:0xf bank_mask:0xc
  v_add_f32_dpp v67, v75, v75 row_ror:8 row_mask:0xf bank_mask:0xc
  v_add_f32_dpp v60, v60, v60 row_half_mirror row_mask:0xf bank_mask:0x5
  v_add_f32_dpp v61, v61, v61 row_half_mirror row_mask:0xf bank_mask:0x5
  v_add_f32_dpp v62, v62, v62 row_half_mirror row_mask:0xf bank_mask:0x5
  v_add_f32_dpp v63, v63, v63 row_half_mirror row_mask:0xf bank_mask:0x5
  v_add_f32_dpp v60, v64, v64 row_half_mirror row_mask:0xf bank_mask:0xa
  v_add_f32_dpp v61, v65, v65 row_half_mirror row_mask:0xf bank_mask:0xa
  v_add_f32_dpp v62, v66, v66 row_half_mirror row_mask:0xf bank_mask:0xa
  v_add_f32_dpp v63, v67, v67 row_half_mirror row_mask:0xf bank_mask:0xa
  v_add_f32_dpp v68, v60, v60 quad_perm:[2,3,0,1] row_mask:0xf bank_mask:0xf
  v_add_f32_dpp v69, v61, v61 quad_perm:[2,3,0,1] row_mask:0xf bank_mask:0xf
  v_add_f32_dpp v70, v62, v62 quad_perm:[2,3,0,1] row_mask:0xf bank_mask:0xf
  v_add_f32_dpp v71, v63, v63 quad_perm:[2,3,0,1] row_mask:0xf bank_mask:0xf
  v_cndmask_b32 v60, v68, v70, s[82:83]
  v_cndmask_b32 v61, v69, v71, s[82:83]
  s_nop 0
  v_add_f32_dpp v68, v60, v60 quad_perm:[1,0,3,2] row_mask:0xf bank_mask:0xf
  v_add_f32_dpp v69, v61, v61 quad_perm:[1,0,3,2] row_mask:0xf bank_mask:0xf
  v_cndmask_b32 v94, v68, v69, s[84:85]
  v_cvt_pk_bf16_f32 v94, v94, v94
  v_lshlrev_b32 v94, 16, v94
  v_mul_f32 v94, 0x3db504f3, v94
  v_cvt_pk_bf16_f32 v94, v94, v94
  v_lshlrev_b32 v94, 16, v94
  v_mov_b32 v16, 0xff800000
  v_cmp_gt_u32 vcc, 4, v3
  s_nop 1
  v_cndmask_b32 v94, v16, v94, vcc
  v_mov_b32 v98, v94
  s_nop 1
  v_max_f32_dpp v16, v98, v98 quad_perm:[1,0,3,2] row_mask:0xf bank_mask:0xf
  s_nop 1
  v_max_f32_dpp v98, v16, v16 quad_perm:[2,3,0,1] row_mask:0xf bank_mask:0xf
  s_nop 1
  v_max_f32_dpp v16, v98, v98 row_half_mirror row_mask:0xf bank_mask:0xf
  s_nop 1
  v_max_f32_dpp v98, v16, v16 row_mirror row_mask:0xf bank_mask:0xf
  v_mov_b32 v16, v98
  s_nop 1
  v_permlane16_swap_b32 v98, v16
  v_max_f32 v98, v98, v16
  v_mov_b32 v16, v98
  s_nop 1
  v_permlane32_swap_b32 v98, v16
  v_max_f32 v98, v98, v16
  v_sub_f32 v16, v94, v98
  v_mul_f32 v16, 0x3fb8aa3b, v16
  v_exp_f32 v16, v16
  s_nop 0
  v_mov_b32 v99, v16
  v_cvt_pk_bf16_f32 v20, v16, v16
  v_lshlrev_b32 v20, 16, v20
  v_sub_f32 v20, v16, v20
  v_cvt_pk_bf16_f32 v96, v16, v20
  v_add_f32_dpp v24, v99, v99 quad_perm:[1,0,3,2] row_mask:0xf bank_mask:0xf
  s_nop 1
  v_add_f32_dpp v99, v24, v24 quad_perm:[2,3,0,1] row_mask:0xf bank_mask:0xf
  s_nop 1
  v_add_f32_dpp v24, v99, v99 row_half_mirror row_mask:0xf bank_mask:0xf
  s_nop 1
  v_add_f32_dpp v99, v24, v24 row_mirror row_mask:0xf bank_mask:0xf
  v_mov_b32 v24, v99
  s_nop 1
  v_permlane16_swap_b32 v99, v24
  v_add_f32 v99, v99, v24
  v_mov_b32 v24, v99
  s_nop 1
  v_permlane32_swap_b32 v99, v24
  v_add_f32 v99, v99, v24
  s_lshl_b32 s92, s3, 3
  v_mov_b32 v16, s92
  ds_write_b64 v16, v[98:99] offset:256
  v_and_b32 v16, 1, v4
  v_lshlrev_b32 v16, 4, v16
  v_lshl_add_u32 v16, v3, 5, v16
  v_lshrrev_b32 v17, 1, v4
  v_lshl_add_u32 v16, v17, 9, v16
  s_lshl_b32 s92, s3, 10
  v_add_u32 v49, s92, v16
  v_lshrrev_b32 v17, 2, v3
  v_lshl_add_u32 v18, v4, 3, v17
  v_mul_u32_u24 v18, 160, v18
  v_and_b32 v19, 3, v3
  v_lshl_add_u32 v18, v19, 3, v18
  s_min_u32 s92, s3, 4
  s_lshl_b32 s92, s92, 5
  v_add_u32 v46, s92, v18
  v_lshl_add_u32 v17, v4, 2, v17
  v_lshrrev_b32 v18, 1, v19
  s_and_b32 s92, s3, 3
  s_lshl_b32 s92, s92, 1
  v_add_u32 v18, s92, v18
  v_and_b32 v20, 7, v17
  v_xor_b32 v18, v18, v20
  v_lshlrev_b32 v18, 4, v18
  v_lshl_add_u32 v18, v17, 7, v18
  v_and_b32 v19, 1, v19
  v_lshl_add_u32 v18, v19, 3, v18
  s_lshr_b32 s92, s3, 2
  s_mul_i32 s92, s92, 10240
  s_add_u32 s92, s92, 38912
  v_add_u32 v47, s92, v18
  v_add_u32 v48, 59392, v46
  v_mov_b32_dpp v92, v96 row_newbcast:0 row_mask:0xf bank_mask:0xf
  v_perm_b32 v84, v92, v92, v5
  v_perm_b32 v85, v92, v92, v6
  v_perm_b32 v86, v92, v92, v7
  v_perm_b32 v87, v92, v92, v8
  v_mov_b32_dpp v93, v96 row_newbcast:1 row_mask:0xf bank_mask:0xf
  v_perm_b32 v88, v93, v93, v5
  v_perm_b32 v89, v93, v93, v6
  v_perm_b32 v90, v93, v93, v7
  v_perm_b32 v91, v93, v93, v8
  s_waitcnt vmcnt(6)
  v_mfma_f32_16x16x32_bf16 v[80:83], v[84:87], v[116:119], 0
  v_mov_b32_dpp v92, v96 row_newbcast:2 row_mask:0xf bank_mask:0xf
  v_perm_b32 v84, v92, v92, v5
  v_perm_b32 v85, v92, v92, v6
  v_perm_b32 v86, v92, v92, v7
  v_perm_b32 v87, v92, v92, v8
  s_waitcnt vmcnt(5)
  v_mfma_f32_16x16x32_bf16 v[80:83], v[88:91], v[120:123], v[80:83]
  v_mov_b32_dpp v93, v96 row_newbcast:3 row_mask:0xf bank_mask:0xf
  v_perm_b32 v88, v93, v93, v5
  v_perm_b32 v89, v93, v93, v6
  v_perm_b32 v90, v93, v93, v7
  v_perm_b32 v91, v93, v93, v8
  s_waitcnt vmcnt(4)
  v_mfma_f32_16x16x32_bf16 v[80:83], v[84:87], v[124:127], v[80:83]
  s_waitcnt vmcnt(3)
  v_mfma_f32_16x16x32_bf16 v[80:83], v[88:91], v[128:131], v[80:83]
  s_waitcnt vmcnt(0)
  s_branch L_vdone
L_kissue:
  buffer_load_dwordx4 v[116:119], v2, s[28:31], s69 offen nt
  s_add_u32 s69, s69, 7168
  s_waitcnt vmcnt(4)
  buffer_load_dwordx4 v[120:123], v2, s[28:31], s69 offen nt
  s_add_u32 s69, s69, 7168
  s_waitcnt vmcnt(4)
  v_lshrrev_b32 v16, 5, v1
  v_and_b32 v17, 31, v1
  v_min_u32 v17, 19, v17
  v_bfe_u32 v18, v1, 2, 1
  v_and_b32 v19, 3, v1
  s_lshl_b32 s92, s78, 2
  v_add_u32 v19, s92, v19
  s_cmp_eq_u32 s77, 1
  s_cselect_b64 s[86:87], -1, 0
  v_cndmask_b32 v16, v18, v16, s[86:87]
  v_cndmask_b32 v17, v19, v17, s[86:87]
  v_mul_u32_u24 v16, 1280, v16
  v_lshl_add_u32 v16, v17, 3, v16
  s_mul_i32 s92, s67, 160
  v_add_u32 v16, s92, v16
  global_load_dwordx2 v[12:13], v16, s[4:5]
  v_mov_b32 v17, 0
  global_load_dword v10, v17, s[22:23]
  v_and_b32 v16, 8, v3
  v_cmp_ne_u32 vcc, 0, v16
  v_mov_b32 v17, 0x0100
  v_mov_b32 v18, 0x0302
  v_cndmask_b32 v17, v17, v18, vcc
  v_lshlrev_b32 v18, 16, v17
  v_or_b32 v18, 0x0c0c, v18
  v_or_b32 v17, 0x0c0c0000, v17
  v_and_b32 v16, 1, v3
  v_cmp_ne_u32 vcc, 0, v16
  s_nop 1
  v_cndmask_b32 v17, v17, v18, vcc
  v_bfe_u32 v16, v3, 1, 2
  v_mov_b32 v18, 0x0c0c0c0c
  v_cmp_eq_u32 vcc, 0, v16
  s_nop 1
  v_cndmask_b32 v5, v18, v17, vcc
  v_cmp_eq_u32 vcc, 1, v16
  s_nop 1
  v_cndmask_b32 v6, v18, v17, vcc
  v_cmp_eq_u32 vcc, 2, v16
  s_nop 1
  v_cndmask_b32 v7, v18, v17, vcc
  v_cmp_eq_u32 vcc, 3, v16
  s_nop 1
  v_cndmask_b32 v8, v18, v17, vcc
  buffer_load_dwordx4 v[124:127], v2, s[28:31], s69 offen nt
  s_add_u32 s69, s69, 7168
  s_waitcnt vmcnt(4)
  buffer_load_dwordx4 v[128:131], v2, s[28:31], s69 offen nt
  s_add_u32 s69, s69, 7168
  s_waitcnt vmcnt(4)
  buffer_load_dwordx4 v[132:135], v2, s[28:31], s69 offen nt
  s_add_u32 s69, s69, 7168
  s_waitcnt vmcnt(4)
  buffer_load_dwordx4 v[136:139], v2, s[28:31], s69 offen nt
  s_add_u32 s69, s69, 7168
  s_waitcnt vmcnt(4)
  buffer_load_dwordx4 v[140:143], v2, s[28:31], s69 offen nt
  s_add_u32 s69, s69, 7168
  s_waitcnt vmcnt(4)
  buffer_load_dwordx4 v[144:147], v2, s[28:31], s69 offen nt
  s_add_u32 s69, s69, 7168
  s_waitcnt vmcnt(4)
  buffer_load_dwordx4 v[148:151], v2, s[28:31], s69 offen nt
  s_add_u32 s69, s69, 7168
  s_waitcnt vmcnt(4)
  buffer_load_dwordx4 v[152:155], v2, s[28:31], s69 offen nt
  s_add_u32 s69, s69, 7168
  s_waitcnt vmcnt(4)
  buffer_load_dwordx4 v[156:159], v2, s[28:31], s69 offen nt
  s_add_u32 s69, s69, 7168
  s_waitcnt vmcnt(4)
  buffer_load_dwordx4 v[160:163], v2, s[28:31], s69 offen nt
  s_add_u32 s69, s69, 7168
  s_waitcnt vmcnt(4)
  buffer_load_dwordx4 v[164:167], v2, s[28:31], s69 offen nt
  s_add_u32 s69, s69, 7168
  s_waitcnt vmcnt(4)
  buffer_load_dwordx4 v[168:171], v2, s[28:31], s69 offen nt
  s_add_u32 s69, s69, 7168
  s_waitcnt vmcnt(4)
  buffer_load_dwordx4 v[172:175], v2, s[28:31], s69 offen nt
  s_add_u32 s69, s69, 7168
  s_waitcnt vmcnt(4)
  buffer_load_dwordx4 v[176:179], v2, s[28:31], s69 offen nt
  s_add_u32 s69, s69, 7168
  s_waitcnt vmcnt(4)
  buffer_load_dwordx4 v[180:183], v2, s[28:31], s69 offen nt
  s_add_u32 s69, s69, 7168
  s_waitcnt vmcnt(4)
  buffer_load_dwordx4 v[184:187], v2, s[28:31], s69 offen nt
  s_add_u32 s69, s69, 7168
  s_waitcnt vmcnt(4)
  buffer_load_dwordx4 v[188:191], v2, s[28:31], s69 offen nt
  s_add_u32 s69, s69, 7168
  s_waitcnt vmcnt(4)
  buffer_load_dwordx4 v[192:195], v2, s[28:31], s69 offen nt
  s_add_u32 s69, s69, 7168
  s_waitcnt vmcnt(4)
  buffer_load_dwordx4 v[196:199], v2, s[28:31], s69 offen nt
  s_add_u32 s69, s69, 7168
  s_waitcnt vmcnt(4)
  buffer_load_dwordx4 v[200:203], v2, s[28:31], s69 offen nt
  s_add_u32 s69, s69, 7168
  s_waitcnt vmcnt(4)
  buffer_load_dwordx4 v[204:207], v2, s[28:31], s69 offen nt
  s_add_u32 s69, s69, 7168
  s_waitcnt vmcnt(4)
  buffer_load_dwordx4 v[208:211], v2, s[28:31], s69 offen nt
  s_add_u32 s69, s69, 7168
  s_waitcnt vmcnt(4)
  buffer_load_dwordx4 v[212:215], v2, s[28:31], s69 offen nt
  s_add_u32 s69, s69, 7168
  s_waitcnt vmcnt(4)
  buffer_load_dwordx4 v[216:219], v2, s[28:31], s69 offen nt
  s_add_u32 s69, s69, 7168
  s_waitcnt vmcnt(4)
  buffer_load_dwordx4 v[220:223], v2, s[28:31], s69 offen nt
  s_add_u32 s69, s69, 7168
  s_waitcnt vmcnt(4)
  buffer_load_dwordx4 v[224:227], v2, s[28:31], s69 offen nt
  s_add_u32 s69, s69, 7168
  s_waitcnt vmcnt(4)
  s_barrier
  v_lshlrev_b32 v16, 4, v3
  ds_read_b128 v[76:79], v16 offset:0
  v_mov_b32 v17, 384
  ds_read_b32 v17, v17
  s_waitcnt lgkmcnt(0)
  v_readfirstlane_b32 s80, v17
  s_waitcnt vmcnt(33)
  v_dot2_f32_bf16 v60, v100, v76, 0
  s_nop 2
  v_dot2_f32_bf16 v60, v101, v77, v60
  s_nop 2
  v_dot2_f32_bf16 v60, v102, v78, v60
  s_nop 2
  v_dot2_f32_bf16 v60, v103, v79, v60
  buffer_load_dwordx4 v[228:231], v2, s[28:31], s69 offen nt
  s_add_u32 s69, s69, 7168
  s_waitcnt vmcnt(8)
  s_waitcnt vmcnt(33)
  v_dot2_f32_bf16 v61, v104, v76, 0
  s_nop 2
  v_dot2_f32_bf16 v61, v105, v77, v61
  s_nop 2
  v_dot2_f32_bf16 v61, v106, v78, v61
  s_nop 2
  v_dot2_f32_bf16 v61, v107, v79, v61
  buffer_load_dwordx4 v[232:235], v2, s[28:31], s69 offen nt
  s_add_u32 s69, s69, 7168
  s_waitcnt vmcnt(8)
  s_waitcnt vmcnt(33)
  v_dot2_f32_bf16 v62, v108, v76, 0
  s_nop 2
  v_dot2_f32_bf16 v62, v109, v77, v62
  s_nop 2
  v_dot2_f32_bf16 v62, v110, v78, v62
  s_nop 2
  v_dot2_f32_bf16 v62, v111, v79, v62
  buffer_load_dwordx4 v[236:239], v2, s[28:31], s69 offen nt
  s_add_u32 s69, s69, 7168
  s_waitcnt vmcnt(8)
  s_waitcnt vmcnt(33)
  v_dot2_f32_bf16 v63, v112, v76, 0
  s_nop 2
  v_dot2_f32_bf16 v63, v113, v77, v63
  s_nop 2
  v_dot2_f32_bf16 v63, v114, v78, v63
  s_nop 2
  v_dot2_f32_bf16 v63, v115, v79, v63
  buffer_load_dwordx4 v[240:243], v2, s[28:31], s69 offen nt
  s_waitcnt vmcnt(8)
  s_waitcnt vmcnt(33)
  v_dot2_f32_bf16 v64, v116, v76, 0
  s_nop 2
  v_dot2_f32_bf16 v64, v117, v77, v64
  s_nop 2
  v_dot2_f32_bf16 v64, v118, v78, v64
  s_nop 2
  v_dot2_f32_bf16 v64, v119, v79, v64
  buffer_load_dwordx4 v[100:103], v2, s[32:35], s70 offen nt
  s_add_u32 s70, s70, 7168
  s_waitcnt vmcnt(8)
  s_waitcnt vmcnt(33)
  v_dot2_f32_bf16 v65, v120, v76, 0
  s_nop 2
  v_dot2_f32_bf16 v65, v121, v77, v65
  s_nop 2
  v_dot2_f32_bf16 v65, v122, v78, v65
  s_nop 2
  v_dot2_f32_bf16 v65, v123, v79, v65
  buffer_load_dwordx4 v[104:107], v2, s[32:35], s70 offen nt
  s_add_u32 s70, s70, 7168
  s_waitcnt vmcnt(8)
  s_waitcnt vmcnt(31)
  v_dot2_f32_bf16 v66, v124, v76, 0
  s_nop 2
  v_dot2_f32_bf16 v66, v125, v77, v66
  s_nop 2
  v_dot2_f32_bf16 v66, v126, v78, v66
  s_nop 2
  v_dot2_f32_bf16 v66, v127, v79, v66
  buffer_load_dwordx4 v[108:111], v2, s[32:35], s70 offen nt
  s_add_u32 s70, s70, 7168
  s_waitcnt vmcnt(8)
  s_waitcnt vmcnt(31)
  v_dot2_f32_bf16 v67, v128, v76, 0
  s_nop 2
  v_dot2_f32_bf16 v67, v129, v77, v67
  s_nop 2
  v_dot2_f32_bf16 v67, v130, v78, v67
  s_nop 2
  v_dot2_f32_bf16 v67, v131, v79, v67
  buffer_load_dwordx4 v[112:115], v2, s[32:35], s70 offen nt
  s_add_u32 s70, s70, 7168
  s_waitcnt vmcnt(8)
  s_waitcnt vmcnt(31)
  v_dot2_f32_bf16 v68, v132, v76, 0
  s_nop 2
  v_dot2_f32_bf16 v68, v133, v77, v68
  s_nop 2
  v_dot2_f32_bf16 v68, v134, v78, v68
  s_nop 2
  v_dot2_f32_bf16 v68, v135, v79, v68
  buffer_load_dwordx4 v[116:119], v2, s[32:35], s70 offen nt
  s_add_u32 s70, s70, 7168
  s_waitcnt vmcnt(8)
  s_waitcnt vmcnt(31)
  v_dot2_f32_bf16 v69, v136, v76, 0
  s_nop 2
  v_dot2_f32_bf16 v69, v137, v77, v69
  s_nop 2
  v_dot2_f32_bf16 v69, v138, v78, v69
  s_nop 2
  v_dot2_f32_bf16 v69, v139, v79, v69
  buffer_load_dwordx4 v[120:123], v2, s[32:35], s70 offen nt
  s_add_u32 s70, s70, 7168
  s_waitcnt vmcnt(8)
  s_waitcnt vmcnt(31)
  v_dot2_f32_bf16 v70, v140, v76, 0
  s_nop 2
  v_dot2_f32_bf16 v70, v141, v77, v70
  s_nop 2
  v_dot2_f32_bf16 v70, v142, v78, v70
  s_nop 2
  v_dot2_f32_bf16 v70, v143, v79, v70
  buffer_load_dwordx4 v[124:127], v2, s[32:35], s70 offen nt
  s_add_u32 s70, s70, 7168
  s_waitcnt vmcnt(8)
  s_waitcnt vmcnt(31)
  v_dot2_f32_bf16 v71, v144, v76, 0
  s_nop 2
  v_dot2_f32_bf16 v71, v145, v77, v71
  s_nop 2
  v_dot2_f32_bf16 v71, v146, v78, v71
  s_nop 2
  v_dot2_f32_bf16 v71, v147, v79, v71
  buffer_load_dwordx4 v[128:131], v2, s[32:35], s70 offen nt
  s_add_u32 s70, s70, 7168
  s_waitcnt vmcnt(8)
  s_waitcnt vmcnt(31)
  v_dot2_f32_bf16 v72, v148, v76, 0
  s_nop 2
  v_dot2_f32_bf16 v72, v149, v77, v72
  s_nop 2
  v_dot2_f32_bf16 v72, v150, v78, v72
  s_nop 2
  v_dot2_f32_bf16 v72, v151, v79, v72
  buffer_load_dwordx4 v[132:135], v2, s[32:35], s70 offen nt
  s_add_u32 s70, s70, 7168
  s_waitcnt vmcnt(8)
  s_waitcnt vmcnt(31)
  v_dot2_f32_bf16 v73, v152, v76, 0
  s_nop 2
  v_dot2_f32_bf16 v73, v153, v77, v73
  s_nop 2
  v_dot2_f32_bf16 v73, v154, v78, v73
  s_nop 2
  v_dot2_f32_bf16 v73, v155, v79, v73
  buffer_load_dwordx4 v[136:139], v2, s[32:35], s70 offen nt
  s_add_u32 s70, s70, 7168
  s_waitcnt vmcnt(8)
  s_waitcnt vmcnt(31)
  v_dot2_f32_bf16 v74, v156, v76, 0
  s_nop 2
  v_dot2_f32_bf16 v74, v157, v77, v74
  s_nop 2
  v_dot2_f32_bf16 v74, v158, v78, v74
  s_nop 2
  v_dot2_f32_bf16 v74, v159, v79, v74
  buffer_load_dwordx4 v[140:143], v2, s[32:35], s70 offen nt
  s_add_u32 s70, s70, 7168
  s_waitcnt vmcnt(8)
  s_waitcnt vmcnt(31)
  v_dot2_f32_bf16 v75, v160, v76, 0
  s_nop 2
  v_dot2_f32_bf16 v75, v161, v77, v75
  s_nop 2
  v_dot2_f32_bf16 v75, v162, v78, v75
  s_nop 2
  v_dot2_f32_bf16 v75, v163, v79, v75
  buffer_load_dwordx4 v[144:147], v2, s[32:35], s70 offen nt
  s_add_u32 s70, s70, 7168
  s_waitcnt vmcnt(8)
  v_add_f32_dpp v60, v60, v60 row_ror:8 row_mask:0xf bank_mask:0x3
  v_add_f32_dpp v61, v61, v61 row_ror:8 row_mask:0xf bank_mask:0x3
  v_add_f32_dpp v62, v62, v62 row_ror:8 row_mask:0xf bank_mask:0x3
  v_add_f32_dpp v63, v63, v63 row_ror:8 row_mask:0xf bank_mask:0x3
  v_add_f32_dpp v64, v64, v64 row_ror:8 row_mask:0xf bank_mask:0x3
  v_add_f32_dpp v65, v65, v65 row_ror:8 row_mask:0xf bank_mask:0x3
  v_add_f32_dpp v66, v66, v66 row_ror:8 row_mask:0xf bank_mask:0x3
  v_add_f32_dpp v67, v67, v67 row_ror:8 row_mask:0xf bank_mask:0x3
  v_add_f32_dpp v60, v68, v68 row_ror:8 row_mask:0xf bank_mask:0xc
  v_add_f32_dpp v61, v69, v69 row_ror:8 row_mask:0xf bank_mask:0xc
  v_add_f32_dpp v62, v70, v70 row_ror:8 row_mask:0xf bank_mask:0xc
  v_add_f32_dpp v63, v71, v71 row_ror:8 row_mask:0xf bank_mask:0xc
  v_add_f32_dpp v64, v72, v72 row_ror:8 row_mask:0xf bank_mask:0xc
  v_add_f32_dpp v65, v73, v73 row_ror:8 row_mask:0xf bank_mask:0xc
  v_add_f32_dpp v66, v74, v74 row_ror:8 row_mask:0xf bank_mask:0xc
  v_add_f32_dpp v67, v75, v75 row_ror:8 row_mask:0xf bank_mask:0xc
  v_add_f32_dpp v60, v60, v60 row_half_mirror row_mask:0xf bank_mask:0x5
  v_add_f32_dpp v61, v61, v61 row_half_mirror row_mask:0xf bank_mask:0x5
  v_add_f32_dpp v62, v62, v62 row_half_mirror row_mask:0xf bank_mask:0x5
  v_add_f32_dpp v63, v63, v63 row_half_mirror row_mask:0xf bank_mask:0x5
  v_add_f32_dpp v60, v64, v64 row_half_mirror row_mask:0xf bank_mask:0xa
  v_add_f32_dpp v61, v65, v65 row_half_mirror row_mask:0xf bank_mask:0xa
  v_add_f32_dpp v62, v66, v66 row_half_mirror row_mask:0xf bank_mask:0xa
  v_add_f32_dpp v63, v67, v67 row_half_mirror row_mask:0xf bank_mask:0xa
  v_add_f32_dpp v68, v60, v60 quad_perm:[2,3,0,1] row_mask:0xf bank_mask:0xf
  v_add_f32_dpp v69, v61, v61 quad_perm:[2,3,0,1] row_mask:0xf bank_mask:0xf
  v_add_f32_dpp v70, v62, v62 quad_perm:[2,3,0,1] row_mask:0xf bank_mask:0xf
  v_add_f32_dpp v71, v63, v63 quad_perm:[2,3,0,1] row_mask:0xf bank_mask:0xf
  v_cndmask_b32 v60, v68, v70, s[82:83]
  v_cndmask_b32 v61, v69, v71, s[82:83]
  s_nop 0
  v_add_f32_dpp v68, v60, v60 quad_perm:[1,0,3,2] row_mask:0xf bank_mask:0xf
  v_add_f32_dpp v69, v61, v61 quad_perm:[1,0,3,2] row_mask:0xf bank_mask:0xf
  v_cndmask_b32 v94, v68, v69, s[84:85]
  s_waitcnt vmcnt(31)
  v_dot2_f32_bf16 v60, v164, v76, 0
  s_nop 2
  v_dot2_f32_bf16 v60, v165, v77, v60
  s_nop 2
  v_dot2_f32_bf16 v60, v166, v78, v60
  s_nop 2
  v_dot2_f32_bf16 v60, v167, v79, v60
  buffer_load_dwordx4 v[148:151], v2, s[32:35], s70 offen nt
  s_add_u32 s70, s70, 7168
  s_waitcnt vmcnt(8)
  s_waitcnt vmcnt(31)
  v_dot2_f32_bf16 v61, v168, v76, 0
  s_nop 2
  v_dot2_f32_bf16 v61, v169, v77, v61
  s_nop 2
  v_dot2_f32_bf16 v61, v170, v78, v61
  s_nop 2
  v_dot2_f32_bf16 v61, v171, v79, v61
  buffer_load_dwordx4 v[152:155], v2, s[32:35], s70 offen nt
  s_add_u32 s70, s70, 7168
  s_waitcnt vmcnt(8)
  s_waitcnt vmcnt(31)
  v_dot2_f32_bf16 v62, v172, v76, 0
  s_nop 2
  v_dot2_f32_bf16 v62, v173, v77, v62
  s_nop 2
  v_dot2_f32_bf16 v62, v174, v78, v62
  s_nop 2
  v_dot2_f32_bf16 v62, v175, v79, v62
  buffer_load_dwordx4 v[156:159], v2, s[32:35], s70 offen nt
  s_add_u32 s70, s70, 7168
  s_waitcnt vmcnt(8)
  s_waitcnt vmcnt(31)
  v_dot2_f32_bf16 v63, v176, v76, 0
  s_nop 2
  v_dot2_f32_bf16 v63, v177, v77, v63
  s_nop 2
  v_dot2_f32_bf16 v63, v178, v78, v63
  s_nop 2
  v_dot2_f32_bf16 v63, v179, v79, v63
  buffer_load_dwordx4 v[160:163], v2, s[32:35], s70 offen nt
  s_add_u32 s70, s70, 7168
  s_waitcnt vmcnt(8)
  s_waitcnt vmcnt(31)
  v_dot2_f32_bf16 v64, v180, v76, 0
  s_nop 2
  v_dot2_f32_bf16 v64, v181, v77, v64
  s_nop 2
  v_dot2_f32_bf16 v64, v182, v78, v64
  s_nop 2
  v_dot2_f32_bf16 v64, v183, v79, v64
  buffer_load_dwordx4 v[164:167], v2, s[32:35], s70 offen nt
  s_add_u32 s70, s70, 7168
  s_waitcnt vmcnt(8)
  s_waitcnt vmcnt(31)
  v_dot2_f32_bf16 v65, v184, v76, 0
  s_nop 2
  v_dot2_f32_bf16 v65, v185, v77, v65
  s_nop 2
  v_dot2_f32_bf16 v65, v186, v78, v65
  s_nop 2
  v_dot2_f32_bf16 v65, v187, v79, v65
  buffer_load_dwordx4 v[168:171], v2, s[32:35], s70 offen nt
  s_add_u32 s70, s70, 7168
  s_waitcnt vmcnt(8)
  s_waitcnt vmcnt(31)
  v_dot2_f32_bf16 v66, v188, v76, 0
  s_nop 2
  v_dot2_f32_bf16 v66, v189, v77, v66
  s_nop 2
  v_dot2_f32_bf16 v66, v190, v78, v66
  s_nop 2
  v_dot2_f32_bf16 v66, v191, v79, v66
  buffer_load_dwordx4 v[172:175], v2, s[32:35], s70 offen nt
  s_add_u32 s70, s70, 7168
  s_waitcnt vmcnt(8)
  s_waitcnt vmcnt(31)
  v_dot2_f32_bf16 v67, v192, v76, 0
  s_nop 2
  v_dot2_f32_bf16 v67, v193, v77, v67
  s_nop 2
  v_dot2_f32_bf16 v67, v194, v78, v67
  s_nop 2
  v_dot2_f32_bf16 v67, v195, v79, v67
  buffer_load_dwordx4 v[176:179], v2, s[32:35], s70 offen nt
  s_add_u32 s70, s70, 7168
  s_waitcnt vmcnt(8)
  s_waitcnt vmcnt(31)
  v_dot2_f32_bf16 v68, v196, v76, 0
  s_nop 2
  v_dot2_f32_bf16 v68, v197, v77, v68
  s_nop 2
  v_dot2_f32_bf16 v68, v198, v78, v68
  s_nop 2
  v_dot2_f32_bf16 v68, v199, v79, v68
  buffer_load_dwordx4 v[180:183], v2, s[32:35], s70 offen nt
  s_add_u32 s70, s70, 7168
  s_waitcnt vmcnt(8)
  s_waitcnt vmcnt(31)
  v_dot2_f32_bf16 v69, v200, v76, 0
  s_nop 2
  v_dot2_f32_bf16 v69, v201, v77, v69
  s_nop 2
  v_dot2_f32_bf16 v69, v202, v78, v69
  s_nop 2
  v_dot2_f32_bf16 v69, v203, v79, v69
  buffer_load_dwordx4 v[184:187], v2, s[32:35], s70 offen nt
  s_add_u32 s70, s70, 7168
  s_waitcnt vmcnt(8)
  s_waitcnt vmcnt(31)
  v_dot2_f32_bf16 v70, v204, v76, 0
  s_nop 2
  v_dot2_f32_bf16 v70, v205, v77, v70
  s_nop 2
  v_dot2_f32_bf16 v70, v206, v78, v70
  s_nop 2
  v_dot2_f32_bf16 v70, v207, v79, v70
  buffer_load_dwordx4 v[188:191], v2, s[32:35], s70 offen nt
  s_add_u32 s70, s70, 7168
  s_waitcnt vmcnt(8)
  s_waitcnt vmcnt(31)
  v_dot2_f32_bf16 v71, v208, v76, 0
  s_nop 2
  v_dot2_f32_bf16 v71, v209, v77, v71
  s_nop 2
  v_dot2_f32_bf16 v71, v210, v78, v71
  s_nop 2
  v_dot2_f32_bf16 v71, v211, v79, v71
  buffer_load_dwordx4 v[192:195], v2, s[32:35], s70 offen nt
  s_add_u32 s70, s70, 7168
  s_waitcnt vmcnt(8)
  s_waitcnt vmcnt(31)
  v_dot2_f32_bf16 v72, v212, v76, 0
  s_nop 2
  v_dot2_f32_bf16 v72, v213, v77, v72
  s_nop 2
  v_dot2_f32_bf16 v72, v214, v78, v72
  s_nop 2
  v_dot2_f32_bf16 v72, v215, v79, v72
  buffer_load_dwordx4 v[196:199], v2, s[32:35], s70 offen nt
  s_add_u32 s70, s70, 7168
  s_waitcnt vmcnt(8)
  s_waitcnt vmcnt(31)
  v_dot2_f32_bf16 v73, v216, v76, 0
  s_nop 2
  v_dot2_f32_bf16 v73, v217, v77, v73
  s_nop 2
  v_dot2_f32_bf16 v73, v218, v78, v73
  s_nop 2
  v_dot2_f32_bf16 v73, v219, v79, v73
  buffer_load_dwordx4 v[200:203], v2, s[32:35], s70 offen nt
  s_add_u32 s70, s70, 7168
  s_waitcnt vmcnt(8)
  s_waitcnt vmcnt(31)
  v_dot2_f32_bf16 v74, v220, v76, 0
  s_nop 2
  v_dot2_f32_bf16 v74, v221, v77, v74
  s_nop 2
  v_dot2_f32_bf16 v74, v222, v78, v74
  s_nop 2
  v_dot2_f32_bf16 v74, v223, v79, v74
  buffer_load_dwordx4 v[204:207], v2, s[32:35], s70 offen nt
  s_add_u32 s70, s70, 7168
  s_waitcnt vmcnt(8)
  s_waitcnt vmcnt(31)
  v_dot2_f32_bf16 v75, v224, v76, 0
  s_nop 2
  v_dot2_f32_bf16 v75, v225, v77, v75
  s_nop 2
  v_dot2_f32_bf16 v75, v226, v78, v75
  s_nop 2
  v_dot2_f32_bf16 v75, v227, v79, v75
  buffer_load_dwordx4 v[208:211], v2, s[32:35], s70 offen nt
  s_add_u32 s70, s70, 7168
  s_waitcnt vmcnt(8)
  v_add_f32_dpp v60, v60, v60 row_ror:8 row_mask:0xf bank_mask:0x3
  v_add_f32_dpp v61, v61, v61 row_ror:8 row_mask:0xf bank_mask:0x3
  v_add_f32_dpp v62, v62, v62 row_ror:8 row_mask:0xf bank_mask:0x3
  v_add_f32_dpp v63, v63, v63 row_ror:8 row_mask:0xf bank_mask:0x3
  v_add_f32_dpp v64, v64, v64 row_ror:8 row_mask:0xf bank_mask:0x3
  v_add_f32_dpp v65, v65, v65 row_ror:8 row_mask:0xf bank_mask:0x3
  v_add_f32_dpp v66, v66, v66 row_ror:8 row_mask:0xf bank_mask:0x3
  v_add_f32_dpp v67, v67, v67 row_ror:8 row_mask:0xf bank_mask:0x3
  v_add_f32_dpp v60, v68, v68 row_ror:8 row_mask:0xf bank_mask:0xc
  v_add_f32_dpp v61, v69, v69 row_ror:8 row_mask:0xf bank_mask:0xc
  v_add_f32_dpp v62, v70, v70 row_ror:8 row_mask:0xf bank_mask:0xc
  v_add_f32_dpp v63, v71, v71 row_ror:8 row_mask:0xf bank_mask:0xc
  v_add_f32_dpp v64, v72, v72 row_ror:8 row_mask:0xf bank_mask:0xc
  v_add_f32_dpp v65, v73, v73 row_ror:8 row_mask:0xf bank_mask:0xc
  v_add_f32_dpp v66, v74, v74 row_ror:8 row_mask:0xf bank_mask:0xc
  v_add_f32_dpp v67, v75, v75 row_ror:8 row_mask:0xf bank_mask:0xc
  v_add_f32_dpp v60, v60, v60 row_half_mirror row_mask:0xf bank_mask:0x5
  v_add_f32_dpp v61, v61, v61 row_half_mirror row_mask:0xf bank_mask:0x5
  v_add_f32_dpp v62, v62, v62 row_half_mirror row_mask:0xf bank_mask:0x5
  v_add_f32_dpp v63, v63, v63 row_half_mirror row_mask:0xf bank_mask:0x5
  v_add_f32_dpp v60, v64, v64 row_half_mirror row_mask:0xf bank_mask:0xa
  v_add_f32_dpp v61, v65, v65 row_half_mirror row_mask:0xf bank_mask:0xa
  v_add_f32_dpp v62, v66, v66 row_half_mirror row_mask:0xf bank_mask:0xa
  v_add_f32_dpp v63, v67, v67 row_half_mirror row_mask:0xf bank_mask:0xa
  v_add_f32_dpp v68, v60, v60 quad_perm:[2,3,0,1] row_mask:0xf bank_mask:0xf
  v_add_f32_dpp v69, v61, v61 quad_perm:[2,3,0,1] row_mask:0xf bank_mask:0xf
  v_add_f32_dpp v70, v62, v62 quad_perm:[2,3,0,1] row_mask:0xf bank_mask:0xf
  v_add_f32_dpp v71, v63, v63 quad_perm:[2,3,0,1] row_mask:0xf bank_mask:0xf
  v_cndmask_b32 v60, v68, v70, s[82:83]
  v_cndmask_b32 v61, v69, v71, s[82:83]
  s_nop 0
  v_add_f32_dpp v68, v60, v60 quad_perm:[1,0,3,2] row_mask:0xf bank_mask:0xf
  v_add_f32_dpp v69, v61, v61 quad_perm:[1,0,3,2] row_mask:0xf bank_mask:0xf
  v_cndmask_b32 v95, v68, v69, s[84:85]
  s_waitcnt vmcnt(31)
  v_dot2_f32_bf16 v60, v228, v76, 0
  s_nop 2
  v_dot2_f32_bf16 v60, v229, v77, v60
  s_nop 2
  v_dot2_f32_bf16 v60, v230, v78, v60
  s_nop 2
  v_dot2_f32_bf16 v60, v231, v79, v60
  buffer_load_dwordx4 v[212:215], v2, s[32:35], s70 offen nt
  s_add_u32 s70, s70, 7168
  s_waitcnt vmcnt(8)
  s_waitcnt vmcnt(31)
  v_dot2_f32_bf16 v61, v232, v76, 0
  s_nop 2
  v_dot2_f32_bf16 v61, v233, v77, v61
  s_nop 2
  v_dot2_f32_bf16 v61, v234, v78, v61
  s_nop 2
  v_dot2_f32_bf16 v61, v235, v79, v61
  buffer_load_dwordx4 v[216:219], v2, s[32:35], s70 offen nt
  s_add_u32 s70, s70, 7168
  s_waitcnt vmcnt(8)
  s_waitcnt vmcnt(31)
  v_dot2_f32_bf16 v62, v236, v76, 0
  s_nop 2
  v_dot2_f32_bf16 v62, v237, v77, v62
  s_nop 2
  v_dot2_f32_bf16 v62, v238, v78, v62
  s_nop 2
  v_dot2_f32_bf16 v62, v239, v79, v62
  buffer_load_dwordx4 v[220:223], v2, s[32:35], s70 offen nt
  s_add_u32 s70, s70, 7168
  s_waitcnt vmcnt(8)
  s_waitcnt vmcnt(31)
  v_dot2_f32_bf16 v63, v240, v76, 0
  s_nop 2
  v_dot2_f32_bf16 v63, v241, v77, v63
  s_nop 2
  v_dot2_f32_bf16 v63, v242, v78, v63
  s_nop 2
  v_dot2_f32_bf16 v63, v243, v79, v63
  buffer_load_dwordx4 v[224:227], v2, s[32:35], s70 offen nt
  s_add_u32 s70, s70, 7168
  s_waitcnt vmcnt(8)
  v_mov_b32 v64, 0
  v_mov_b32 v65, 0
  v_mov_b32 v66, 0
  v_mov_b32 v67, 0
  v_mov_b32 v68, 0
  v_mov_b32 v69, 0
  v_mov_b32 v70, 0
  v_mov_b32 v71, 0
  v_mov_b32 v72, 0
  v_mov_b32 v73, 0
  v_mov_b32 v74, 0
  v_mov_b32 v75, 0
  v_add_f32_dpp v60, v60, v60 row_ror:8 row_mask:0xf bank_mask:0x3
  v_add_f32_dpp v61, v61, v61 row_ror:8 row_mask:0xf bank_mask:0x3
  v_add_f32_dpp v62, v62, v62 row_ror:8 row_mask:0xf bank_mask:0x3
  v_add_f32_dpp v63, v63, v63 row_ror:8 row_mask:0xf bank_mask:0x3
  v_add_f32_dpp v64, v64, v64 row_ror:8 row_mask:0xf bank_mask:0x3
  v_add_f32_dpp v65, v65, v65 row_ror:8 row_mask:0xf bank_mask:0x3
  v_add_f32_dpp v66, v66, v66 row_ror:8 row_mask:0xf bank_mask:0x3
  v_add_f32_dpp v67, v67, v67 row_ror:8 row_mask:0xf bank_mask:0x3
  v_add_f32_dpp v60, v68, v68 row_ror:8 row_mask:0xf bank_mask:0xc
  v_add_f32_dpp v61, v69, v69 row_ror:8 row_mask:0xf bank_mask:0xc
  v_add_f32_dpp v62, v70, v70 row_ror:8 row_mask:0xf bank_mask:0xc
  v_add_f32_dpp v63, v71, v71 row_ror:8 row_mask:0xf bank_mask:0xc
  v_add_f32_dpp v64, v72, v72 row_ror:8 row_mask:0xf bank_mask:0xc
  v_add_f32_dpp v65, v73, v73 row_ror:8 row_mask:0xf bank_mask:0xc
  v_add_f32_dpp v66, v74, v74 row_ror:8 row_mask:0xf bank_mask:0xc
  v_add_f32_dpp v67, v75, v75 row_ror:8 row_mask:0xf bank_mask:0xc
  v_add_f32_dpp v60, v60, v60 row_half_mirror row_mask:0xf bank_mask:0x5
  v_add_f32_dpp v61, v61, v61 row_half_mirror row_mask:0xf bank_mask:0x5
  v_add_f32_dpp v62, v62, v62 row_half_mirror row_mask:0xf bank_mask:0x5
  v_add_f32_dpp v63, v63, v63 row_half_mirror row_mask:0xf bank_mask:0x5
  v_add_f32_dpp v60, v64, v64 row_half_mirror row_mask:0xf bank_mask:0xa
  v_add_f32_dpp v61, v65, v65 row_half_mirror row_mask:0xf bank_mask:0xa
  v_add_f32_dpp v62, v66, v66 row_half_mirror row_mask:0xf bank_mask:0xa
  v_add_f32_dpp v63, v67, v67 row_half_mirror row_mask:0xf bank_mask:0xa
  v_add_f32_dpp v68, v60, v60 quad_perm:[2,3,0,1] row_mask:0xf bank_mask:0xf
  v_add_f32_dpp v69, v61, v61 quad_perm:[2,3,0,1] row_mask:0xf bank_mask:0xf
  v_add_f32_dpp v70, v62, v62 quad_perm:[2,3,0,1] row_mask:0xf bank_mask:0xf
  v_add_f32_dpp v71, v63, v63 quad_perm:[2,3,0,1] row_mask:0xf bank_mask:0xf
  v_cndmask_b32 v60, v68, v70, s[82:83]
  v_cndmask_b32 v61, v69, v71, s[82:83]
  s_nop 0
  v_add_f32_dpp v68, v60, v60 quad_perm:[1,0,3,2] row_mask:0xf bank_mask:0xf
  v_add_f32_dpp v69, v61, v61 quad_perm:[1,0,3,2] row_mask:0xf bank_mask:0xf
  v_cndmask_b32 v14, v68, v69, s[84:85]
  v_cvt_pk_bf16_f32 v94, v94, v94
  v_lshlrev_b32 v94, 16, v94
  v_cvt_pk_bf16_f32 v95, v95, v95
  v_lshlrev_b32 v95, 16, v95
  v_cvt_pk_bf16_f32 v14, v14, v14
  v_lshlrev_b32 v14, 16, v14
  v_mul_f32 v94, 0x3db504f3, v94
  v_mul_f32 v95, 0x3db504f3, v95
  v_mul_f32 v14, 0x3db504f3, v14
  v_cvt_pk_bf16_f32 v94, v94, v94
  v_lshlrev_b32 v94, 16, v94
  v_cvt_pk_bf16_f32 v95, v95, v95
  v_lshlrev_b32 v95, 16, v95
  v_cvt_pk_bf16_f32 v14, v14, v14
  v_lshlrev_b32 v14, 16, v14
  v_mov_b32 v16, 0xff800000
  v_cmp_gt_u32 vcc, 4, v3
  s_nop 1
  v_cndmask_b32 v14, v16, v14, vcc
  v_max3_f32 v98, v94, v95, v14
  s_nop 1
  v_max_f32_dpp v16, v98, v98 quad_perm:[1,0,3,2] row_mask:0xf bank_mask:0xf
  s_nop 1
  v_max_f32_dpp v98, v16, v16 quad_perm:[2,3,0,1] row_mask:0xf bank_mask:0xf
  s_nop 1
  v_max_f32_dpp v16, v98, v98 row_half_mirror row_mask:0xf bank_mask:0xf
  s_nop 1
  v_max_f32_dpp v98, v16, v16 row_mirror row_mask:0xf bank_mask:0xf
  v_mov_b32 v16, v98
  s_nop 1
  v_permlane16_swap_b32 v98, v16
  v_max_f32 v98, v98, v16
  v_mov_b32 v16, v98
  s_nop 1
  v_permlane32_swap_b32 v98, v16
  v_max_f32 v98, v98, v16
  v_sub_f32 v16, v94, v98
  v_mul_f32 v16, 0x3fb8aa3b, v16
  v_exp_f32 v16, v16
  v_sub_f32 v17, v95, v98
  v_mul_f32 v17, 0x3fb8aa3b, v17
  v_exp_f32 v17, v17
  v_sub_f32 v18, v14, v98
  v_mul_f32 v18, 0x3fb8aa3b, v18
  v_exp_f32 v18, v18
  v_mov_b32 v99, v16
  v_add_f32 v99, v99, v17
  v_add_f32 v99, v99, v18
  v_cvt_pk_bf16_f32 v20, v16, v16
  v_lshlrev_b32 v20, 16, v20
  v_sub_f32 v20, v16, v20
  v_cvt_pk_bf16_f32 v96, v16, v20
  v_cvt_pk_bf16_f32 v21, v17, v17
  v_lshlrev_b32 v21, 16, v21
  v_sub_f32 v21, v17, v21
  v_cvt_pk_bf16_f32 v97, v17, v21
  v_cvt_pk_bf16_f32 v22, v18, v18
  v_lshlrev_b32 v22, 16, v22
  v_sub_f32 v22, v18, v22
  v_cvt_pk_bf16_f32 v15, v18, v22
  v_add_f32_dpp v24, v99, v99 quad_perm:[1,0,3,2] row_mask:0xf bank_mask:0xf
  s_nop 1
  v_add_f32_dpp v99, v24, v24 quad_perm:[2,3,0,1] row_mask:0xf bank_mask:0xf
  s_nop 1
  v_add_f32_dpp v24, v99, v99 row_half_mirror row_mask:0xf bank_mask:0xf
  s_nop 1
  v_add_f32_dpp v99, v24, v24 row_mirror row_mask:0xf bank_mask:0xf
  v_mov_b32 v24, v99
  s_nop 1
  v_permlane16_swap_b32 v99, v24
  v_add_f32 v99, v99, v24
  v_mov_b32 v24, v99
  s_nop 1
  v_permlane32_swap_b32 v99, v24
  v_add_f32 v99, v99, v24
  s_lshl_b32 s92, s3, 3
  v_mov_b32 v16, s92
  ds_write_b64 v16, v[98:99] offset:256
  v_and_b32 v16, 1, v4
  v_lshlrev_b32 v16, 4, v16
  v_lshl_add_u32 v16, v3, 5, v16
  v_lshrrev_b32 v17, 1, v4
  v_lshl_add_u32 v16, v17, 9, v16
  s_lshl_b32 s92, s3, 10
  v_add_u32 v49, s92, v16
  v_lshrrev_b32 v17, 2, v3
  v_lshl_add_u32 v18, v4, 3, v17
  v_mul_u32_u24 v18, 160, v18
  v_and_b32 v19, 3, v3
  v_lshl_add_u32 v18, v19, 3, v18
  s_min_u32 s92, s3, 4
  s_lshl_b32 s92, s92, 5
  v_add_u32 v46, s92, v18
  v_lshl_add_u32 v17, v4, 2, v17
  v_lshrrev_b32 v18, 1, v19
  s_and_b32 s92, s3, 3
  s_lshl_b32 s92, s92, 1
  v_add_u32 v18, s92, v18
  v_and_b32 v20, 7, v17
  v_xor_b32 v18, v18, v20
  v_lshlrev_b32 v18, 4, v18
  v_lshl_add_u32 v18, v17, 7, v18
  v_and_b32 v19, 1, v19
  v_lshl_add_u32 v18, v19, 3, v18
  s_lshr_b32 s92, s3, 2
  s_mul_i32 s92, s92, 10240
  s_add_u32 s92, s92, 38912
  v_add_u32 v47, s92, v18
  v_add_u32 v48, 59392, v46
  v_mov_b32_dpp v92, v96 row_newbcast:0 row_mask:0xf bank_mask:0xf
  v_perm_b32 v84, v92, v92, v5
  v_perm_b32 v85, v92, v92, v6
  v_perm_b32 v86, v92, v92, v7
  v_perm_b32 v87, v92, v92, v8
  buffer_load_dwordx4 v[228:231], v2, s[32:35], s70 offen nt
  s_add_u32 s70, s70, 7168
  s_waitcnt vmcnt(8)
  v_mov_b32_dpp v93, v96 row_newbcast:1 row_mask:0xf bank_mask:0xf
  v_perm_b32 v88, v93, v93, v5
  v_perm_b32 v89, v93, v93, v6
  v_perm_b32 v90, v93, v93, v7
  v_perm_b32 v91, v93, v93, v8
  s_waitcnt vmcnt(32)
  v_mfma_f32_16x16x32_bf16 v[80:83], v[84:87], v[100:103], 0
  buffer_load_dwordx4 v[232:235], v2, s[32:35], s70 offen nt
  s_add_u32 s70, s70, 7168
  s_waitcnt vmcnt(8)
  v_mov_b32_dpp v92, v96 row_newbcast:2 row_mask:0xf bank_mask:0xf
  v_perm_b32 v84, v92, v92, v5
  v_perm_b32 v85, v92, v92, v6
  v_perm_b32 v86, v92, v92, v7
  v_perm_b32 v87, v92, v92, v8
  s_waitcnt vmcnt(32)
  v_mfma_f32_16x16x32_bf16 v[80:83], v[88:91], v[104:107], v[80:83]
  buffer_load_dwordx4 v[236:239], v2, s[32:35], s70 offen nt
  s_add_u32 s70, s70, 7168
  s_waitcnt vmcnt(8)
  v_mov_b32_dpp v93, v96 row_newbcast:3 row_mask:0xf bank_mask:0xf
  v_perm_b32 v88, v93, v93, v5
  v_perm_b32 v89, v93, v93, v6
  v_perm_b32 v90, v93, v93, v7
  v_perm_b32 v91, v93, v93, v8
  s_waitcnt vmcnt(32)
  v_mfma_f32_16x16x32_bf16 v[80:83], v[84:87], v[108:111], v[80:83]
  buffer_load_dwordx4 v[240:243], v2, s[32:35], s70 offen nt
  v_lshlrev_b32 v247, 2, v1
  global_load_dword v249, v247, s[24:25] sc1
  s_waitcnt vmcnt(8)
  v_mov_b32_dpp v92, v96 row_newbcast:4 row_mask:0xf bank_mask:0xf
  v_perm_b32 v84, v92, v92, v5
  v_perm_b32 v85, v92, v92, v6
  v_perm_b32 v86, v92, v92, v7
  v_perm_b32 v87, v92, v92, v8
  s_waitcnt vmcnt(33)
  v_mfma_f32_16x16x32_bf16 v[80:83], v[88:91], v[112:115], v[80:83]
  v_mov_b32_dpp v93, v96 row_newbcast:5 row_mask:0xf bank_mask:0xf
  v_perm_b32 v88, v93, v93, v5
  v_perm_b32 v89, v93, v93, v6
  v_perm_b32 v90, v93, v93, v7
  v_perm_b32 v91, v93, v93, v8
  s_waitcnt vmcnt(32)
  v_mfma_f32_16x16x32_bf16 v[80:83], v[84:87], v[116:119], v[80:83]
  v_mov_b32_dpp v92, v96 row_newbcast:6 row_mask:0xf bank_mask:0xf
  v_perm_b32 v84, v92, v92, v5
  v_perm_b32 v85, v92, v92, v6
  v_perm_b32 v86, v92, v92, v7
  v_perm_b32 v87, v92, v92, v8
  s_waitcnt vmcnt(31)
  v_mfma_f32_16x16x32_bf16 v[80:83], v[88:91], v[120:123], v[80:83]
  v_mov_b32_dpp v93, v96 row_newbcast:7 row_mask:0xf bank_mask:0xf
  v_perm_b32 v88, v93, v93, v5
  v_perm_b32 v89, v93, v93, v6
  v_perm_b32 v90, v93, v93, v7
  v_perm_b32 v91, v93, v93, v8
  s_waitcnt vmcnt(30)
  v_mfma_f32_16x16x32_bf16 v[80:83], v[84:87], v[124:127], v[80:83]
  v_mov_b32_dpp v92, v96 row_newbcast:8 row_mask:0xf bank_mask:0xf
  v_perm_b32 v84, v92, v92, v5
  v_perm_b32 v85, v92, v92, v6
  v_perm_b32 v86, v92, v92, v7
  v_perm_b32 v87, v92, v92, v8
  s_waitcnt vmcnt(29)
  v_mfma_f32_16x16x32_bf16 v[80:83], v[88:91], v[128:131], v[80:83]
  v_mov_b32_dpp v93, v96 row_newbcast:9 row_mask:0xf bank_mask:0xf
  v_perm_b32 v88, v93, v93, v5
  v_perm_b32 v89, v93, v93, v6
  v_perm_b32 v90, v93, v93, v7
  v_perm_b32 v91, v93, v93, v8
  s_waitcnt vmcnt(28)
  v_mfma_f32_16x16x32_bf16 v[80:83], v[84:87], v[132:135], v[80:83]
  v_mov_b32_dpp v92, v96 row_newbcast:10 row_mask:0xf bank_mask:0xf
  v_perm_b32 v84, v92, v92, v5
  v_perm_b32 v85, v92, v92, v6
  v_perm_b32 v86, v92, v92, v7
  v_perm_b32 v87, v92, v92, v8
  s_waitcnt vmcnt(27)
  v_mfma_f32_16x16x32_bf16 v[80:83], v[88:91], v[136:139], v[80:83]
  v_mov_b32_dpp v93, v96 row_newbcast:11 row_mask:0xf bank_mask:0xf
  v_perm_b32 v88, v93, v93, v5
  v_perm_b32 v89, v93, v93, v6
  v_perm_b32 v90, v93, v93, v7
  v_perm_b32 v91, v93, v93, v8
  s_waitcnt vmcnt(26)
  v_mfma_f32_16x16x32_bf16 v[80:83], v[84:87], v[140:143], v[80:83]
  v_mov_b32_dpp v92, v96 row_newbcast:12 row_mask:0xf bank_mask:0xf
  v_perm_b32 v84, v92, v92, v5
  v_perm_b32 v85, v92, v92, v6
  v_perm_b32 v86, v92, v92, v7
  v_perm_b32 v87, v92, v92, v8
  s_waitcnt vmcnt(25)
  v_mfma_f32_16x16x32_bf16 v[80:83], v[88:91], v[144:147], v[80:83]
  v_mov_b32_dpp v93, v96 row_newbcast:13 row_mask:0xf bank_mask:0xf
  v_perm_b32 v88, v93, v93, v5
  v_perm_b32 v89, v93, v93, v6
  v_perm_b32 v90, v93, v93, v7
  v_perm_b32 v91, v93, v93, v8
  s_waitcnt vmcnt(24)
  v_mfma_f32_16x16x32_bf16 v[80:83], v[84:87], v[148:151], v[80:83]
  v_mov_b32_dpp v92, v96 row_newbcast:14 row_mask:0xf bank_mask:0xf
  v_perm_b32 v84, v92, v92, v5
  v_perm_b32 v85, v92, v92, v6
  v_perm_b32 v86, v92, v92, v7
  v_perm_b32 v87, v92, v92, v8
  s_waitcnt vmcnt(23)
  v_mfma_f32_16x16x32_bf16 v[80:83], v[88:91], v[152:155], v[80:83]
  v_mov_b32_dpp v93, v96 row_newbcast:15 row_mask:0xf bank_mask:0xf
  v_perm_b32 v88, v93, v93, v5
  v_perm_b32 v89, v93, v93, v6
  v_perm_b32 v90, v93, v93, v7
  v_perm_b32 v91, v93, v93, v8
  s_waitcnt vmcnt(22)
  v_mfma_f32_16x16x32_bf16 v[80:83], v[84:87], v[156:159], v[80:83]
  v_mov_b32_dpp v92, v97 row_newbcast:0 row_mask:0xf bank_mask:0xf
  v_perm_b32 v84, v92, v92, v5
  v_perm_b32 v85, v92, v92, v6
  v_perm_b32 v86, v92, v92, v7
  v_perm_b32 v87, v92, v92, v8
  s_waitcnt vmcnt(21)
  v_mfma_f32_16x16x32_bf16 v[80:83], v[88:91], v[160:163], v[80:83]
  v_mov_b32_dpp v93, v97 row_newbcast:1 row_mask:0xf bank_mask:0xf
  v_perm_b32 v88, v93, v93, v5
  v_perm_b32 v89, v93, v93, v6
  v_perm_b32 v90, v93, v93, v7
  v_perm_b32 v91, v93, v93, v8
  s_waitcnt vmcnt(20)
  v_mfma_f32_16x16x32_bf16 v[80:83], v[84:87], v[164:167], v[80:83]
  v_mov_b32_dpp v92, v97 row_newbcast:2 row_mask:0xf bank_mask:0xf
  v_perm_b32 v84, v92, v92, v5
  v_perm_b32 v85, v92, v92, v6
  v_perm_b32 v86, v92, v92, v7
  v_perm_b32 v87, v92, v92, v8
  s_waitcnt vmcnt(19)
  v_mfma_f32_16x16x32_bf16 v[80:83], v[88:91], v[168:171], v[80:83]
  v_mov_b32_dpp v93, v97 row_newbcast:3 row_mask:0xf bank_mask:0xf
  v_perm_b32 v88, v93, v93, v5
  v_perm_b32 v89, v93, v93, v6
  v_perm_b32 v90, v93, v93, v7
  v_perm_b32 v91, v93, v93, v8
  s_waitcnt vmcnt(18)
  v_mfma_f32_16x16x32_bf16 v[80:83], v[84:87], v[172:175], v[80:83]
  v_mov_b32_dpp v92, v97 row_newbcast:4 row_mask:0xf bank_mask:0xf
  v_perm_b32 v84, v92, v92, v5
  v_perm_b32 v85, v92, v92, v6
  v_perm_b32 v86, v92, v92, v7
  v_perm_b32 v87, v92, v92, v8
  s_waitcnt vmcnt(17)
  v_mfma_f32_16x16x32_bf16 v[80:83], v[88:91], v[176:179], v[80:83]
  v_mov_b32_dpp v93, v97 row_newbcast:5 row_mask:0xf bank_mask:0xf
  v_perm_b32 v88, v93, v93, v5
  v_perm_b32 v89, v93, v93, v6
  v_perm_b32 v90, v93, v93, v7
  v_perm_b32 v91, v93, v93, v8
  s_waitcnt vmcnt(16)
  v_mfma_f32_16x16x32_bf16 v[80:83], v[84:87], v[180:183], v[80:83]
  v_mov_b32_dpp v92, v97 row_newbcast:6 row_mask:0xf bank_mask:0xf
  v_perm_b32 v84, v92, v92, v5
  v_perm_b32 v85, v92, v92, v6
  v_perm_b32 v86, v92, v92, v7
  v_perm_b32 v87, v92, v92, v8
  s_waitcnt vmcnt(15)
  v_mfma_f32_16x16x32_bf16 v[80:83], v[88:91], v[184:187], v[80:83]
  v_mov_b32_dpp v93, v97 row_newbcast:7 row_mask:0xf bank_mask:0xf
  v_perm_b32 v88, v93, v93, v5
  v_perm_b32 v89, v93, v93, v6
  v_perm_b32 v90, v93, v93, v7
  v_perm_b32 v91, v93, v93, v8
  s_waitcnt vmcnt(14)
  v_mfma_f32_16x16x32_bf16 v[80:83], v[84:87], v[188:191], v[80:83]
  v_mov_b32_dpp v92, v97 row_newbcast:8 row_mask:0xf bank_mask:0xf
  v_perm_b32 v84, v92, v92, v5
  v_perm_b32 v85, v92, v92, v6
  v_perm_b32 v86, v92, v92, v7
  v_perm_b32 v87, v92, v92, v8
  s_waitcnt vmcnt(13)
  v_mfma_f32_16x16x32_bf16 v[80:83], v[88:91], v[192:195], v[80:83]
  v_mov_b32_dpp v93, v97 row_newbcast:9 row_mask:0xf bank_mask:0xf
  v_perm_b32 v88, v93, v93, v5
  v_perm_b32 v89, v93, v93, v6
  v_perm_b32 v90, v93, v93, v7
  v_perm_b32 v91, v93, v93, v8
  s_waitcnt vmcnt(12)
  v_mfma_f32_16x16x32_bf16 v[80:83], v[84:87], v[196:199], v[80:83]
  v_mov_b32_dpp v92, v97 row_newbcast:10 row_mask:0xf bank_mask:0xf
  v_perm_b32 v84, v92, v92, v5
  v_perm_b32 v85, v92, v92, v6
  v_perm_b32 v86, v92, v92, v7
  v_perm_b32 v87, v92, v92, v8
  s_waitcnt vmcnt(11)
  v_mfma_f32_16x16x32_bf16 v[80:83], v[88:91], v[200:203], v[80:83]
  v_mov_b32_dpp v93, v97 row_newbcast:11 row_mask:0xf bank_mask:0xf
  v_perm_b32 v88, v93, v93, v5
  v_perm_b32 v89, v93, v93, v6
  v_perm_b32 v90, v93, v93, v7
  v_perm_b32 v91, v93, v93, v8
  s_waitcnt vmcnt(10)
  v_mfma_f32_16x16x32_bf16 v[80:83], v[84:87], v[204:207], v[80:83]
  v_mov_b32_dpp v92, v97 row_newbcast:12 row_mask:0xf bank_mask:0xf
  v_perm_b32 v84, v92, v92, v5
  v_perm_b32 v85, v92, v92, v6
  v_perm_b32 v86, v92, v92, v7
  v_perm_b32 v87, v92, v92, v8
  s_waitcnt vmcnt(9)
  v_mfma_f32_16x16x32_bf16 v[80:83], v[88:91], v[208:211], v[80:83]
  v_mov_b32_dpp v93, v97 row_newbcast:13 row_mask:0xf bank_mask:0xf
  v_perm_b32 v88, v93, v93, v5
  v_perm_b32 v89, v93, v93, v6
  v_perm_b32 v90, v93, v93, v7
  v_perm_b32 v91, v93, v93, v8
  s_waitcnt vmcnt(8)
  v_mfma_f32_16x16x32_bf16 v[80:83], v[84:87], v[212:215], v[80:83]
  v_mov_b32_dpp v92, v97 row_newbcast:14 row_mask:0xf bank_mask:0xf
  v_perm_b32 v84, v92, v92, v5
  v_perm_b32 v85, v92, v92, v6
  v_perm_b32 v86, v92, v92, v7
  v_perm_b32 v87, v92, v92, v8
  s_waitcnt vmcnt(7)
  v_mfma_f32_16x16x32_bf16 v[80:83], v[88:91], v[216:219], v[80:83]
  v_mov_b32_dpp v93, v97 row_newbcast:15 row_mask:0xf bank_mask:0xf
  v_perm_b32 v88, v93, v93, v5
  v_perm_b32 v89, v93, v93, v6
  v_perm_b32 v90, v93, v93, v7
  v_perm_b32 v91, v93, v93, v8
  s_waitcnt vmcnt(6)
  v_mfma_f32_16x16x32_bf16 v[80:83], v[84:87], v[220:223], v[80:83]
  v_mov_b32_dpp v92, v15 row_newbcast:0 row_mask:0xf bank_mask:0xf
  v_perm_b32 v84, v92, v92, v5
  v_perm_b32 v85, v92, v92, v6
  v_perm_b32 v86, v92, v92, v7
  v_perm_b32 v87, v92, v92, v8
  s_waitcnt vmcnt(5)
  v_mfma_f32_16x16x32_bf16 v[80:83], v[88:91], v[224:227], v[80:83]
  v_mov_b32_dpp v93, v15 row_newbcast:1 row_mask:0xf bank_mask:0xf
  v_perm_b32 v88, v93, v93, v5
  v_perm_b32 v89, v93, v93, v6
  v_perm_b32 v90, v93, v93, v7
  v_perm_b32 v91, v93, v93, v8
  s_waitcnt vmcnt(4)
  v_mfma_f32_16x16x32_bf16 v[80:83], v[84:87], v[228:231], v[80:83]
  v_mov_b32_dpp v92, v15 row_newbcast:2 row_mask:0xf bank_mask:0xf
  v_perm_b32 v84, v92, v92, v5
  v_perm_b32 v85, v92, v92, v6
  v_perm_b32 v86, v92, v92, v7
  v_perm_b32 v87, v92, v92, v8
  s_waitcnt vmcnt(3)
  v_mfma_f32_16x16x32_bf16 v[80:83], v[88:91], v[232:235], v[80:83]
  v_mov_b32_dpp v93, v15 row_newbcast:3 row_mask:0xf bank_mask:0xf
  v_perm_b32 v88, v93, v93, v5
  v_perm_b32 v89, v93, v93, v6
  v_perm_b32 v90, v93, v93, v7
  v_perm_b32 v91, v93, v93, v8
  s_waitcnt vmcnt(2)
  v_mfma_f32_16x16x32_bf16 v[80:83], v[84:87], v[236:239], v[80:83]
  s_waitcnt vmcnt(1)
  v_mfma_f32_16x16x32_bf16 v[80:83], v[88:91], v[240:243], v[80:83]
  s_waitcnt vmcnt(0)
L_vdone:
  s_nop 7
  ds_write_b128 v49, v[80:83] offset:1024
  s_waitcnt lgkmcnt(0)
  s_barrier
  s_cmp_eq_u32 s3, 0
  s_cbranch_scc1 L_w0comb
  ds_read_b64_tr_b16 v[196:197], v46 offset:18432
  ds_read_b64_tr_b16 v[198:199], v46 offset:19072
  ds_read_b64_tr_b16 v[200:201], v46 offset:23552
  ds_read_b64_tr_b16 v[202:203], v46 offset:24192
  ds_read_b64_tr_b16 v[204:205], v46 offset:28672
  ds_read_b64_tr_b16 v[206:207], v46 offset:29312
  ds_read_b64_tr_b16 v[208:209], v46 offset:33792
  ds_read_b64_tr_b16 v[210:211], v46 offset:34432
  s_waitcnt lgkmcnt(4)
  ds_read_b64_tr_b16 v[212:213], v47 offset:0
  ds_read_b64_tr_b16 v[214:215], v47 offset:2048
  ds_read_b64_tr_b16 v[216:217], v47 offset:4096
  ds_read_b64_tr_b16 v[218:219], v47 offset:6144
  ds_read_b64_tr_b16 v[220:221], v47 offset:8192
  ds_read_b64_tr_b16 v[228:229], v48 offset:0
  ds_read_b64_tr_b16 v[230:231], v48 offset:640
  ds_read_b64_tr_b16 v[232:233], v48 offset:5120
  ds_read_b64_tr_b16 v[234:235], v48 offset:5760
  s_branch L_b3
L_w0comb:
  v_and_b32 v16, 7, v1
  v_lshlrev_b32 v16, 3, v16
  ds_read_b64 v[18:19], v16 offset:256
  ds_read_b128 v[100:103], v2 offset:1024
  ds_read_b128 v[104:107], v2 offset:2048
  ds_read_b128 v[108:111], v2 offset:3072
  ds_read_b128 v[112:115], v2 offset:4096
  ds_read_b128 v[116:119], v2 offset:5120
  ds_read_b128 v[120:123], v2 offset:6144
  ds_read_b128 v[124:127], v2 offset:7168
  ds_read_b128 v[128:131], v2 offset:8192
  s_waitcnt lgkmcnt(8)
  v_max_f32_dpp v20, v18, v18 quad_perm:[1,0,3,2] row_mask:0xf bank_mask:0xf
  s_nop 1
  v_max_f32_dpp v21, v20, v20 quad_perm:[2,3,0,1] row_mask:0xf bank_mask:0xf
  s_nop 1
  v_max_f32_dpp v20, v21, v21 row_half_mirror row_mask:0xf bank_mask:0xf
  v_sub_f32 v21, v18, v20
  v_mul_f32 v21, 0x3fb8aa3b, v21
  v_exp_f32 v21, v21
  s_nop 0
  v_mul_f32 v22, v21, v19
  v_readlane_b32 s48, v21, 0
  v_readlane_b32 s49, v21, 1
  v_readlane_b32 s50, v21, 2
  v_readlane_b32 s51, v21, 3
  v_readlane_b32 s52, v21, 4
  v_readlane_b32 s53, v21, 5
  v_readlane_b32 s54, v21, 6
  v_readlane_b32 s55, v21, 7
  v_add_f32_dpp v23, v22, v22 quad_perm:[1,0,3,2] row_mask:0xf bank_mask:0xf
  s_nop 1
  v_add_f32_dpp v22, v23, v23 quad_perm:[2,3,0,1] row_mask:0xf bank_mask:0xf
  s_nop 1
  v_add_f32_dpp v21, v22, v22 row_half_mirror row_mask:0xf bank_mask:0xf
  s_waitcnt lgkmcnt(0)
  v_mul_f32 v24, s48, v100
  v_mul_f32 v25, s48, v101
  v_mul_f32 v26, s48, v102
  v_mul_f32 v27, s48, v103
  v_fmac_f32 v24, s49, v104
  v_fmac_f32 v25, s49, v105
  v_fmac_f32 v26, s49, v106
  v_fmac_f32 v27, s49, v107
  v_fmac_f32 v24, s50, v108
  v_fmac_f32 v25, s50, v109
  v_fmac_f32 v26, s50, v110
  v_fmac_f32 v27, s50, v111
  v_fmac_f32 v24, s51, v112
  v_fmac_f32 v25, s51, v113
  v_fmac_f32 v26, s51, v114
  v_fmac_f32 v27, s51, v115
  v_fmac_f32 v24, s52, v116
  v_fmac_f32 v25, s52, v117
  v_fmac_f32 v26, s52, v118
  v_fmac_f32 v27, s52, v119
  v_fmac_f32 v24, s53, v120
  v_fmac_f32 v25, s53, v121
  v_fmac_f32 v26, s53, v122
  v_fmac_f32 v27, s53, v123
  v_fmac_f32 v24, s54, v124
  v_fmac_f32 v25, s54, v125
  v_fmac_f32 v26, s54, v126
  v_fmac_f32 v27, s54, v127
  v_fmac_f32 v24, s55, v128
  v_fmac_f32 v25, s55, v129
  v_fmac_f32 v26, s55, v130
  v_fmac_f32 v27, s55, v131
  v_mov_b32 v28, v24
  v_mov_b32 v29, v25
  v_mov_b32 v30, v26
  v_mov_b32 v31, v27
  v_permlane32_swap_b32 v24, v28
  v_permlane32_swap_b32 v25, v29
  v_permlane32_swap_b32 v26, v30
  v_permlane32_swap_b32 v27, v31
  v_add_f32 v24, v24, v28
  v_add_f32 v25, v25, v29
  v_add_f32 v26, v26, v30
  v_add_f32 v27, v27, v31
  v_min_u32 v24, -2, v24
  v_min_u32 v25, -2, v25
  v_min_u32 v26, -2, v26
  v_min_u32 v27, -2, v27
  v_min_u32 v20, -2, v20
  v_min_u32 v21, -2, v21
  s_lshl_b32 s92, s68, 10
  s_add_u32 s92, s92, 262144
  s_add_u32 s92, s92, s80
  v_add_u32 v16, s92, v2
  s_cmp_lg_u32 s80, 0
  s_cbranch_scc1 L_pub0_slow
  s_mov_b32 exec_hi, 0
  global_store_dwordx4 v16, v[24:27], s[26:27]
  s_mov_b64 exec, 1
  global_store_dwordx2 v16, v[20:21], s[26:27] offset:512
  s_mov_b64 exec, -1
  s_branch L_pub0_end
L_pub0_slow:
  s_mov_b32 exec_hi, 0
  global_store_dwordx4 v16, v[24:27], s[26:27] sc1
  s_mov_b64 exec, 1
  global_store_dwordx2 v16, v[20:21], s[26:27] offset:512 sc1
  s_mov_b64 exec, -1
L_pub0_end:
  s_lshl_b32 s92, s64, 13
  s_add_u32 s92, s92, 262144
  s_add_u32 s92, s92, s80
  v_lshrrev_b32 v16, 5, v1
  v_lshlrev_b32 v16, 12, v16
  v_add_u32 v17, s92, v16
  v_and_b32 v18, 31, v1
  v_lshl_add_u32 v16, v18, 4, v17
  s_mov_b32 s96, 0
  global_load_dwordx4 v[100:103], v16, s[26:27] offset:0 sc1
  global_load_dwordx2 v[116:117], v17, s[26:27] offset:512 sc1
  global_load_dwordx4 v[104:107], v16, s[26:27] offset:1024 sc1
  global_load_dwordx2 v[118:119], v17, s[26:27] offset:1536 sc1
  global_load_dwordx4 v[108:111], v16, s[26:27] offset:2048 sc1
  global_load_dwordx2 v[120:121], v17, s[26:27] offset:2560 sc1
  global_load_dwordx4 v[112:115], v16, s[26:27] offset:3072 sc1
  global_load_dwordx2 v[122:123], v17, s[26:27] offset:3584 sc1
  ds_read_b64_tr_b16 v[196:197], v46 offset:18432
  ds_read_b64_tr_b16 v[198:199], v46 offset:19072
  ds_read_b64_tr_b16 v[200:201], v46 offset:23552
  ds_read_b64_tr_b16 v[202:203], v46 offset:24192
  ds_read_b64_tr_b16 v[204:205], v46 offset:28672
  ds_read_b64_tr_b16 v[206:207], v46 offset:29312
  ds_read_b64_tr_b16 v[208:209], v46 offset:33792
  ds_read_b64_tr_b16 v[210:211], v46 offset:34432
  s_waitcnt lgkmcnt(4)
  ds_read_b64_tr_b16 v[212:213], v47 offset:0
  ds_read_b64_tr_b16 v[214:215], v47 offset:2048
  ds_read_b64_tr_b16 v[216:217], v47 offset:4096
  ds_read_b64_tr_b16 v[218:219], v47 offset:6144
  ds_read_b64_tr_b16 v[220:221], v47 offset:8192
  ds_read_b64_tr_b16 v[228:229], v48 offset:0
  ds_read_b64_tr_b16 v[230:231], v48 offset:640
  ds_read_b64_tr_b16 v[232:233], v48 offset:5120
  ds_read_b64_tr_b16 v[234:235], v48 offset:5760
L_po_loop:
  s_waitcnt vmcnt(0)
  v_max_u32 v248, v100, v101
  v_max3_u32 v248, v248, v102, v103
  v_max3_u32 v248, v248, v116, v117
  v_max3_u32 v248, v248, v104, v105
  v_max3_u32 v248, v248, v106, v107
  v_max3_u32 v248, v248, v118, v119
  v_max3_u32 v248, v248, v108, v109
  v_max3_u32 v248, v248, v110, v111
  v_max3_u32 v248, v248, v120, v121
  v_max3_u32 v248, v248, v112, v113
  v_max3_u32 v248, v248, v114, v115
  v_max3_u32 v248, v248, v122, v123
  v_cmp_eq_u32 vcc, -1, v248
  s_nop 0
  s_cmp_eq_u64 vcc, 0
  s_cbranch_scc1 L_po_ok
  s_add_u32 s96, s96, 1
  s_cmp_gt_u32 s96, 200000
  s_cbranch_scc1 L_po_ok
  v_max_u32 v248, v100, v101
  v_max3_u32 v248, v248, v102, v103
  v_max3_u32 v248, v248, v116, v117
  v_cmp_eq_u32 vcc, -1, v248
  s_nop 0
  s_cmp_eq_u64 vcc, 0
  s_cbranch_scc1 L_po_n0
  global_load_dwordx4 v[100:103], v16, s[26:27] offset:0 sc1
  global_load_dwordx2 v[116:117], v17, s[26:27] offset:512 sc1
L_po_n0:
  v_max_u32 v248, v104, v105
  v_max3_u32 v248, v248, v106, v107
  v_max3_u32 v248, v248, v118, v119
  v_cmp_eq_u32 vcc, -1, v248
  s_nop 0
  s_cmp_eq_u64 vcc, 0
  s_cbranch_scc1 L_po_n1
  global_load_dwordx4 v[104:107], v16, s[26:27] offset:1024 sc1
  global_load_dwordx2 v[118:119], v17, s[26:27] offset:1536 sc1
L_po_n1:
  v_max_u32 v248, v108, v109
  v_max3_u32 v248, v248, v110, v111
  v_max3_u32 v248, v248, v120, v121
  v_cmp_eq_u32 vcc, -1, v248
  s_nop 0
  s_cmp_eq_u64 vcc, 0
  s_cbranch_scc1 L_po_n2
  global_load_dwordx4 v[108:111], v16, s[26:27] offset:2048 sc1
  global_load_dwordx2 v[120:121], v17, s[26:27] offset:2560 sc1
L_po_n2:
  v_max_u32 v248, v112, v113
  v_max3_u32 v248, v248, v114, v115
  v_max3_u32 v248, v248, v122, v123
  v_cmp_eq_u32 vcc, -1, v248
  s_nop 0
  s_cmp_eq_u64 vcc, 0
  s_cbranch_scc1 L_po_n3
  global_load_dwordx4 v[112:115], v16, s[26:27] offset:3072 sc1
  global_load_dwordx2 v[122:123], v17, s[26:27] offset:3584 sc1
L_po_n3:
  s_branch L_po_loop
L_po_ok:
  v_max_f32 v20, v116, v118
  v_max3_f32 v20, v20, v120, v122
  v_sub_f32 v116, v116, v20
  v_mul_f32 v116, 0x3fb8aa3b, v116
  v_sub_f32 v118, v118, v20
  v_mul_f32 v118, 0x3fb8aa3b, v118
  v_sub_f32 v120, v120, v20
  v_mul_f32 v120, 0x3fb8aa3b, v120
  v_sub_f32 v122, v122, v20
  v_mul_f32 v122, 0x3fb8aa3b, v122
  v_exp_f32 v116, v116
  v_exp_f32 v118, v118
  v_exp_f32 v120, v120
  v_exp_f32 v122, v122
  v_mul_f32 v21, v116, v117
  v_fmac_f32 v21, v118, v119
  v_fmac_f32 v21, v120, v121
  v_fmac_f32 v21, v122, v123
  v_rcp_f32 v22, v21
  v_mul_f32 v24, v116, v100
  v_mul_f32 v25, v116, v101
  v_mul_f32 v26, v116, v102
  v_mul_f32 v27, v116, v103
  v_fmac_f32 v24, v118, v104
  v_fmac_f32 v25, v118, v105
  v_fmac_f32 v26, v118, v106
  v_fmac_f32 v27, v118, v107
  v_fmac_f32 v24, v120, v108
  v_fmac_f32 v25, v120, v109
  v_fmac_f32 v26, v120, v110
  v_fmac_f32 v27, v120, v111
  v_fmac_f32 v24, v122, v112
  v_fmac_f32 v25, v122, v113
  v_fmac_f32 v26, v122, v114
  v_fmac_f32 v27, v122, v115
  v_mul_f32 v28, v24, v22
  v_mul_f32 v29, v25, v22
  v_mul_f32 v30, v26, v22
  v_mul_f32 v31, v27, v22
  v_fma_f32 v32, -v28, v21, v24
  v_fma_f32 v33, -v29, v21, v25
  v_fma_f32 v34, -v30, v21, v26
  v_fma_f32 v35, -v31, v21, v27
  v_fma_f32 v28, v32, v22, v28
  v_fma_f32 v29, v33, v22, v29
  v_fma_f32 v30, v34, v22, v30
  v_fma_f32 v31, v35, v22, v31
  v_cvt_pk_bf16_f32 v24, v28, v29
  v_cvt_pk_bf16_f32 v25, v30, v31
  v_lshlrev_b32 v16, 3, v1
  ds_write_b64 v16, v[24:25] offset:512
L_b3:
  s_waitcnt lgkmcnt(0)
  s_barrier
  s_cmp_ge_u32 s3, 5
  s_cbranch_scc1 L_zdone
  v_bfe_u32 v16, v3, 2, 1
  v_lshlrev_b32 v16, 8, v16
  v_lshl_add_u32 v16, v4, 4, v16
  ds_read_b128 v[100:103], v16 offset:512
  ds_read_b128 v[104:107], v16 offset:576
  ds_read_b128 v[108:111], v16 offset:640
  ds_read_b128 v[112:115], v16 offset:704
  s_mul_i32 s92, s67, 20480
  s_mul_i32 s93, s64, 640
  s_add_u32 s92, s92, s93
  s_lshl_b32 s93, s3, 6
  s_add_u32 s92, s92, s93
  s_add_u32 s92, s92, 524288
  v_and_b32 v17, 1, v4
  v_mul_u32_u24 v17, 320, v17
  v_lshl_add_u32 v17, v3, 2, v17
  v_add_u32 v17, s92, v17
  s_waitcnt lgkmcnt(3)
  v_mfma_f32_16x16x32_bf16 v[80:83], v[100:103], v[196:199], 0
  s_waitcnt lgkmcnt(2)
  v_mfma_f32_16x16x32_bf16 v[80:83], v[104:107], v[200:203], v[80:83]
  s_waitcnt lgkmcnt(1)
  v_mfma_f32_16x16x32_bf16 v[80:83], v[108:111], v[204:207], v[80:83]
  s_waitcnt lgkmcnt(0)
  v_mfma_f32_16x16x32_bf16 v[80:83], v[112:115], v[208:211], v[80:83]
  s_nop 7
  v_min_u32 v80, -2, v80
  s_mov_b32 exec_hi, 0
  global_store_dword v17, v80, s[26:27] sc1
  s_mov_b32 exec_hi, -1
L_zdone:
  v_lshlrev_b32 v52, 16, v12
  v_and_b32 v53, 0xffff0000, v12
  v_lshlrev_b32 v54, 16, v13
  v_and_b32 v55, 0xffff0000, v13
  s_cmp_eq_u32 s77, 1
  s_cbranch_scc1 L_ffn
  s_cmp_lg_u32 s3, 5
  s_cbranch_scc1 L_end
  v_lshrrev_b32 v16, 3, v1
  v_mul_u32_u24 v16, 640, v16
  v_bfe_u32 v17, v1, 2, 1
  v_mul_u32_u24 v17, 320, v17
  v_add_u32 v16, v16, v17
  v_and_b32 v17, 3, v1
  v_lshl_add_u32 v16, v17, 4, v16
  s_mul_i32 s92, s67, 20480
  s_lshl_b32 s93, s78, 6
  s_add_u32 s92, s92, s93
  s_add_u32 s92, s92, 524288
  v_add_u32 v56, s92, v16
  v_add_u32 v57, 5120, v56
  v_add_u32 v58, 10240, v56
  v_add_u32 v59, 15360, v56
  s_mov_b32 s96, 0
L_fw1_loop:
  v_and_b32 v249, v249, v246
  v_cmp_ne_u32 vcc, v249, v246
  s_nop 0
  s_cmp_eq_u64 vcc, 0
  s_cbranch_scc1 L_fw1_ok
  s_add_u32 s96, s96, 1
  s_cmp_gt_u32 s96, 200000
  s_cbranch_scc1 L_fw1_ok
  v_lshlrev_b32 v247, 2, v1
  global_load_dword v249, v247, s[24:25] sc1
  s_waitcnt vmcnt(0)
  s_branch L_fw1_loop
L_fw1_ok:
  s_mov_b32 s96, 0
  global_load_dwordx4 v[100:103], v56, s[26:27] sc1
  global_load_dwordx4 v[104:107], v57, s[26:27] sc1
  global_load_dwordx4 v[108:111], v58, s[26:27] sc1
  global_load_dwordx4 v[112:115], v59, s[26:27] sc1
L_pz_loop:
  s_waitcnt vmcnt(0)
  v_max_u32 v248, v100, v101
  v_max3_u32 v248, v248, v102, v103
  v_max3_u32 v248, v248, v104, v105
  v_max3_u32 v248, v248, v106, v107
  v_max3_u32 v248, v248, v108, v109
  v_max3_u32 v248, v248, v110, v111
  v_max3_u32 v248, v248, v112, v113
  v_max3_u32 v248, v248, v114, v115
  v_cmp_eq_u32 vcc, -1, v248
  s_nop 0
  s_cmp_eq_u64 vcc, 0
  s_cbranch_scc1 L_pz_ok
  s_add_u32 s96, s96, 1
  s_cmp_gt_u32 s96, 200000
  s_cbranch_scc1 L_pz_ok
  v_max_u32 v248, v100, v101
  v_max3_u32 v248, v248, v102, v103
  v_cmp_eq_u32 vcc, -1, v248
  s_nop 0
  s_cmp_eq_u64 vcc, 0
  s_cbranch_scc1 L_pz_n0
  global_load_dwordx4 v[100:103], v56, s[26:27] sc1
L_pz_n0:
  v_max_u32 v248, v104, v105
  v_max3_u32 v248, v248, v106, v107
  v_cmp_eq_u32 vcc, -1, v248
  s_nop 0
  s_cmp_eq_u64 vcc, 0
  s_cbranch_scc1 L_pz_n1
  global_load_dwordx4 v[104:107], v57, s[26:27] sc1
L_pz_n1:
  v_max_u32 v248, v108, v109
  v_max3_u32 v248, v248, v110, v111
  v_cmp_eq_u32 vcc, -1, v248
  s_nop 0
  s_cmp_eq_u64 vcc, 0
  s_cbranch_scc1 L_pz_n2
  global_load_dwordx4 v[108:111], v58, s[26:27] sc1
L_pz_n2:
  v_max_u32 v248, v112, v113
  v_max3_u32 v248, v248, v114, v115
  v_cmp_eq_u32 vcc, -1, v248
  s_nop 0
  s_cmp_eq_u64 vcc, 0
  s_cbranch_scc1 L_pz_n3
  global_load_dwordx4 v[112:115], v59, s[26:27] sc1
L_pz_n3:
  s_branch L_pz_loop
L_pz_ok:
  v_add_f32 v100, v100, v104
  v_add_f32 v101, v101, v105
  v_add_f32 v102, v102, v106
  v_add_f32 v103, v103, v107
  v_add_f32 v100, v100, v108
  v_add_f32 v101, v101, v109
  v_add_f32 v102, v102, v110
  v_add_f32 v103, v103, v111
  v_add_f32 v100, v100, v112
  v_add_f32 v101, v101, v113
  v_add_f32 v102, v102, v114
  v_add_f32 v103, v103, v115
  v_add_f32_dpp v16, v100, v100 row_ror:8 row_mask:0xf bank_mask:0xf
  v_add_f32_dpp v17, v101, v101 row_ror:8 row_mask:0xf bank_mask:0xf
  v_add_f32_dpp v18, v102, v102 row_ror:8 row_mask:0xf bank_mask:0xf
  v_add_f32_dpp v19, v103, v103 row_ror:8 row_mask:0xf bank_mask:0xf
  v_mov_b32 v100, v16
  v_mov_b32 v101, v17
  v_mov_b32 v102, v18
  v_mov_b32 v103, v19
  v_permlane16_swap_b32 v16, v100
  v_permlane16_swap_b32 v17, v101
  v_permlane16_swap_b32 v18, v102
  v_permlane16_swap_b32 v19, v103
  v_add_f32 v16, v16, v100
  v_add_f32 v17, v17, v101
  v_add_f32 v18, v18, v102
  v_add_f32 v19, v19, v103
  v_mov_b32 v100, v16
  v_mov_b32 v101, v17
  v_mov_b32 v102, v18
  v_mov_b32 v103, v19
  v_permlane32_swap_b32 v16, v100
  v_permlane32_swap_b32 v17, v101
  v_permlane32_swap_b32 v18, v102
  v_permlane32_swap_b32 v19, v103
  v_add_f32 v16, v16, v100
  v_add_f32 v17, v17, v101
  v_add_f32 v18, v18, v102
  v_add_f32 v19, v19, v103
  v_mov_b32 v100, v16
  v_mov_b32 v101, v17
  v_mov_b32 v102, v18
  v_mov_b32 v103, v19
  v_cvt_pk_bf16_f32 v100, v100, v100
  v_lshlrev_b32 v100, 16, v100
  v_add_f32 v24, v52, v100
  v_cvt_pk_bf16_f32 v24, v24, v24
  v_lshlrev_b32 v24, 16, v24
  v_cvt_pk_bf16_f32 v101, v101, v101
  v_lshlrev_b32 v101, 16, v101
  v_add_f32 v25, v53, v101
  v_cvt_pk_bf16_f32 v25, v25, v25
  v_lshlrev_b32 v25, 16, v25
  v_cvt_pk_bf16_f32 v102, v102, v102
  v_lshlrev_b32 v102, 16, v102
  v_add_f32 v26, v54, v102
  v_cvt_pk_bf16_f32 v26, v26, v26
  v_lshlrev_b32 v26, 16, v26
  v_cvt_pk_bf16_f32 v103, v103, v103
  v_lshlrev_b32 v103, 16, v103
  v_add_f32 v27, v55, v103
  v_cvt_pk_bf16_f32 v27, v27, v27
  v_lshlrev_b32 v27, 16, v27
  s_mul_i32 s92, s67, 5
  s_add_u32 s92, s92, s78
  s_mul_i32 s92, s92, 3456
  s_add_u32 s92, s92, 1310720
  s_add_u32 s60, s26, s92
  s_addc_u32 s61, s27, 0
  s_mov_b32 s62, 3456
  s_mov_b32 s63, 0x00020000
  v_bfe_u32 v28, v1, 2, 1
  v_mul_u32_u24 v28, 1280, v28
  v_and_b32 v29, 3, v1
  v_lshl_add_u32 v28, v29, 3, v28
  s_mul_i32 s92, s67, 160
  s_lshl_b32 s93, s78, 5
  s_add_u32 s92, s92, s93
  v_add_u32 v28, s92, v28
  s_mov_b32 s96, 0
  buffer_load_dwordx4 v[100:103], v2, s[60:63], 0 offen offset:0 sc1
  buffer_load_dwordx4 v[104:107], v2, s[60:63], 0 offen offset:1024 sc1
  buffer_load_dwordx4 v[108:111], v2, s[60:63], 0 offen offset:2048 sc1
  buffer_load_dwordx4 v[112:115], v2, s[60:63], 0 offen offset:3072 sc1
L_py_loop:
  s_waitcnt vmcnt(0)
  v_max_u32 v248, v100, v101
  v_max3_u32 v248, v248, v102, v103
  v_max3_u32 v248, v248, v104, v105
  v_max3_u32 v248, v248, v106, v107
  v_max3_u32 v248, v248, v108, v109
  v_max3_u32 v248, v248, v110, v111
  v_max3_u32 v248, v248, v112, v113
  v_max3_u32 v248, v248, v114, v115
  v_cmp_eq_u32 vcc, -1, v248
  s_nop 0
  s_cmp_eq_u64 vcc, 0
  s_cbranch_scc1 L_py_ok
  s_add_u32 s96, s96, 1
  s_cmp_gt_u32 s96, 200000
  s_cbranch_scc1 L_py_ok
  v_max_u32 v248, v100, v101
  v_max3_u32 v248, v248, v102, v103
  v_cmp_eq_u32 vcc, -1, v248
  s_nop 0
  s_cmp_eq_u64 vcc, 0
  s_cbranch_scc1 L_py_n0
  buffer_load_dwordx4 v[100:103], v2, s[60:63], 0 offen offset:0 sc1
L_py_n0:
  v_max_u32 v248, v104, v105
  v_max3_u32 v248, v248, v106, v107
  v_cmp_eq_u32 vcc, -1, v248
  s_nop 0
  s_cmp_eq_u64 vcc, 0
  s_cbranch_scc1 L_py_n1
  buffer_load_dwordx4 v[104:107], v2, s[60:63], 0 offen offset:1024 sc1
L_py_n1:
  v_max_u32 v248, v108, v109
  v_max3_u32 v248, v248, v110, v111
  v_cmp_eq_u32 vcc, -1, v248
  s_nop 0
  s_cmp_eq_u64 vcc, 0
  s_cbranch_scc1 L_py_n2
  buffer_load_dwordx4 v[108:111], v2, s[60:63], 0 offen offset:2048 sc1
L_py_n2:
  v_max_u32 v248, v112, v113
  v_max3_u32 v248, v248, v114, v115
  v_cmp_eq_u32 vcc, -1, v248
  s_nop 0
  s_cmp_eq_u64 vcc, 0
  s_cbranch_scc1 L_py_n3
  buffer_load_dwordx4 v[112:115], v2, s[60:63], 0 offen offset:3072 sc1
L_py_n3:
  s_branch L_py_loop
L_py_ok:
  v_add_f32 v100, v100, v104
  v_add_f32 v101, v101, v105
  v_add_f32 v102, v102, v106
  v_add_f32 v103, v103, v107
  v_add_f32 v100, v100, v108
  v_add_f32 v101, v101, v109
  v_add_f32 v102, v102, v110
  v_add_f32 v103, v103, v111
  v_add_f32 v100, v100, v112
  v_add_f32 v101, v101, v113
  v_add_f32 v102, v102, v114
  v_add_f32 v103, v103, v115
  v_add_f32_dpp v16, v100, v100 row_ror:8 row_mask:0xf bank_mask:0xf
  v_add_f32_dpp v17, v101, v101 row_ror:8 row_mask:0xf bank_mask:0xf
  v_add_f32_dpp v18, v102, v102 row_ror:8 row_mask:0xf bank_mask:0xf
  v_add_f32_dpp v19, v103, v103 row_ror:8 row_mask:0xf bank_mask:0xf
  v_mov_b32 v100, v16
  v_mov_b32 v101, v17
  v_mov_b32 v102, v18
  v_mov_b32 v103, v19
  v_permlane16_swap_b32 v16, v100
  v_permlane16_swap_b32 v17, v101
  v_permlane16_swap_b32 v18, v102
  v_permlane16_swap_b32 v19, v103
  v_add_f32 v16, v16, v100
  v_add_f32 v17, v17, v101
  v_add_f32 v18, v18, v102
  v_add_f32 v19, v19, v103
  v_mov_b32 v100, v16
  v_mov_b32 v101, v17
  v_mov_b32 v102, v18
  v_mov_b32 v103, v19
  v_permlane32_swap_b32 v16, v100
  v_permlane32_swap_b32 v17, v101
  v_permlane32_swap_b32 v18, v102
  v_permlane32_swap_b32 v19, v103
  v_add_f32 v16, v16, v100
  v_add_f32 v17, v17, v101
  v_add_f32 v18, v18, v102
  v_add_f32 v19, v19, v103
  v_mov_b32 v100, v16
  v_mov_b32 v101, v17
  v_mov_b32 v102, v18
  v_mov_b32 v103, v19
  v_cvt_pk_bf16_f32 v100, v100, v100
  v_lshlrev_b32 v100, 16, v100
  v_add_f32 v20, v24, v100
  v_cvt_pk_bf16_f32 v101, v101, v101
  v_lshlrev_b32 v101, 16, v101
  v_add_f32 v21, v25, v101
  v_cvt_pk_bf16_f32 v102, v102, v102
  v_lshlrev_b32 v102, 16, v102
  v_add_f32 v22, v26, v102
  v_cvt_pk_bf16_f32 v103, v103, v103
  v_lshlrev_b32 v103, 16, v103
  v_add_f32 v23, v27, v103
  v_cvt_pk_bf16_f32 v30, v20, v21
  v_cvt_pk_bf16_f32 v31, v22, v23
  s_mov_b64 exec, 0xff
  global_store_dwordx2 v28, v[30:31], s[22:23]
  s_mov_b64 exec, -1
  s_branch L_end
L_ffn:
  v_lshrrev_b32 v16, 5, v1
  v_mul_u32_u24 v16, 320, v16
  v_and_b32 v17, 31, v1
  v_min_u32 v18, 19, v17
  v_lshl_add_u32 v16, v18, 4, v16
  s_mul_i32 s92, s67, 20480
  s_mul_i32 s93, s3, 2560
  s_add_u32 s92, s92, s93
  s_add_u32 s92, s92, 524288
  v_add_u32 v56, s92, v16
  v_lshrrev_b32 v57, 1, v16
  v_cmp_gt_u32 s[88:89], 20, v17
  s_mov_b32 s96, 0
L_fw2_loop:
  v_and_b32 v249, v249, v246
  v_cmp_ne_u32 vcc, v249, v246
  s_nop 0
  s_cmp_eq_u64 vcc, 0
  s_cbranch_scc1 L_fw2_ok
  s_add_u32 s96, s96, 1
  s_cmp_gt_u32 s96, 200000
  s_cbranch_scc1 L_fw2_ok
  v_lshlrev_b32 v247, 2, v1
  global_load_dword v249, v247, s[24:25] sc1
  s_waitcnt vmcnt(0)
  s_branch L_fw2_loop
L_fw2_ok:
  s_mov_b32 s96, 0
  global_load_dwordx4 v[100:103], v56, s[26:27] offset:0 sc1
  global_load_dwordx4 v[104:107], v56, s[26:27] offset:640 sc1
  global_load_dwordx4 v[108:111], v56, s[26:27] offset:1280 sc1
  global_load_dwordx4 v[112:115], v56, s[26:27] offset:1920 sc1
L_pz2_loop:
  s_waitcnt vmcnt(0)
  v_max_u32 v248, v100, v101
  v_max3_u32 v248, v248, v102, v103
  v_max3_u32 v248, v248, v104, v105
  v_max3_u32 v248, v248, v106, v107
  v_max3_u32 v248, v248, v108, v109
  v_max3_u32 v248, v248, v110, v111
  v_max3_u32 v248, v248, v112, v113
  v_max3_u32 v248, v248, v114, v115
  v_cmp_eq_u32 vcc, -1, v248
  s_nop 0
  s_cmp_eq_u64 vcc, 0
  s_cbranch_scc1 L_pz2_ok
  s_add_u32 s96, s96, 1
  s_cmp_gt_u32 s96, 200000
  s_cbranch_scc1 L_pz2_ok
  v_max_u32 v248, v100, v101
  v_max3_u32 v248, v248, v102, v103
  v_cmp_eq_u32 vcc, -1, v248
  s_nop 0
  s_cmp_eq_u64 vcc, 0
  s_cbranch_scc1 L_pz2_n0
  global_load_dwordx4 v[100:103], v56, s[26:27] offset:0 sc1
L_pz2_n0:
  v_max_u32 v248, v104, v105
  v_max3_u32 v248, v248, v106, v107
  v_cmp_eq_u32 vcc, -1, v248
  s_nop 0
  s_cmp_eq_u64 vcc, 0
  s_cbranch_scc1 L_pz2_n1
  global_load_dwordx4 v[104:107], v56, s[26:27] offset:640 sc1
L_pz2_n1:
  v_max_u32 v248, v108, v109
  v_max3_u32 v248, v248, v110, v111
  v_cmp_eq_u32 vcc, -1, v248
  s_nop 0
  s_cmp_eq_u64 vcc, 0
  s_cbranch_scc1 L_pz2_n2
  global_load_dwordx4 v[108:111], v56, s[26:27] offset:1280 sc1
L_pz2_n2:
  v_max_u32 v248, v112, v113
  v_max3_u32 v248, v248, v114, v115
  v_cmp_eq_u32 vcc, -1, v248
  s_nop 0
  s_cmp_eq_u64 vcc, 0
  s_cbranch_scc1 L_pz2_n3
  global_load_dwordx4 v[112:115], v56, s[26:27] offset:1920 sc1
L_pz2_n3:
  s_branch L_pz2_loop
L_pz2_ok:
  v_add_f32 v100, v100, v104
  v_add_f32 v108, v108, v112
  v_add_f32 v101, v101, v105
  v_add_f32 v109, v109, v113
  v_add_f32 v102, v102, v106
  v_add_f32 v110, v110, v114
  v_add_f32 v103, v103, v107
  v_add_f32 v111, v111, v115
  v_add_f32 v100, v100, v108
  v_add_f32 v101, v101, v109
  v_add_f32 v102, v102, v110
  v_add_f32 v103, v103, v111
  s_lshl_b32 s92, s3, 10
  v_add_u32 v16, s92, v2
  ds_write_b128 v16, v[100:103] offset:9216
  s_waitcnt lgkmcnt(0)
  s_barrier
  ds_read_b128 v[100:103], v2 offset:9216
  ds_read_b128 v[104:107], v2 offset:10240
  ds_read_b128 v[108:111], v2 offset:11264
  ds_read_b128 v[112:115], v2 offset:12288
  ds_read_b128 v[116:119], v2 offset:13312
  ds_read_b128 v[120:123], v2 offset:14336
  ds_read_b128 v[124:127], v2 offset:15360
  ds_read_b128 v[128:131], v2 offset:16384
  v_bfe_u32 v16, v3, 2, 1
  v_mul_u32_u24 v16, 160, v16
  v_add_u32 v16, 17408, v16
  v_mov_b32 v17, 17920
  v_cmp_gt_u32 vcc, 8, v3
  s_nop 1
  v_cndmask_b32 v16, v17, v16, vcc
  v_lshl_add_u32 v58, v4, 3, v16
  s_mul_i32 s92, s68, 2304
  s_add_u32 s94, s92, 786432
  s_add_u32 s94, s94, s80
  s_and_b32 s92, s3, 3
  s_lshl_b32 s92, s92, 9
  s_lshr_b32 s93, s3, 2
  s_lshl_b32 s93, s93, 4
  s_add_u32 s92, s92, s93
  s_add_u32 s92, s92, s94
  v_lshlrev_b32 v59, 5, v3
  v_lshl_add_u32 v59, v4, 2, v59
  v_add_u32 v59, s92, v59
  s_waitcnt lgkmcnt(0)
  v_add_f32 v100, v100, v104
  v_add_f32 v108, v108, v112
  v_add_f32 v116, v116, v120
  v_add_f32 v124, v124, v128
  v_add_f32 v101, v101, v105
  v_add_f32 v109, v109, v113
  v_add_f32 v117, v117, v121
  v_add_f32 v125, v125, v129
  v_add_f32 v102, v102, v106
  v_add_f32 v110, v110, v114
  v_add_f32 v118, v118, v122
  v_add_f32 v126, v126, v130
  v_add_f32 v103, v103, v107
  v_add_f32 v111, v111, v115
  v_add_f32 v119, v119, v123
  v_add_f32 v127, v127, v131
  v_add_f32 v100, v100, v108
  v_add_f32 v116, v116, v124
  v_add_f32 v101, v101, v109
  v_add_f32 v117, v117, v125
  v_add_f32 v102, v102, v110
  v_add_f32 v118, v118, v126
  v_add_f32 v103, v103, v111
  v_add_f32 v119, v119, v127
  v_add_f32 v100, v100, v116
  v_add_f32 v101, v101, v117
  v_add_f32 v102, v102, v118
  v_add_f32 v103, v103, v119
  v_cvt_pk_bf16_f32 v100, v100, v100
  v_lshlrev_b32 v100, 16, v100
  v_add_f32 v24, v52, v100
  v_cvt_pk_bf16_f32 v101, v101, v101
  v_lshlrev_b32 v101, 16, v101
  v_add_f32 v25, v53, v101
  v_cvt_pk_bf16_f32 v102, v102, v102
  v_lshlrev_b32 v102, 16, v102
  v_add_f32 v26, v54, v102
  v_cvt_pk_bf16_f32 v103, v103, v103
  v_lshlrev_b32 v103, 16, v103
  v_add_f32 v27, v55, v103
  v_cvt_pk_bf16_f32 v28, v24, v25
  v_cvt_pk_bf16_f32 v29, v26, v27
  ds_write_b64 v57, v[28:29] offset:17408
  s_waitcnt lgkmcnt(0)
  ds_read_b64 v[100:101], v58 offset:0
  ds_read_b64 v[102:103], v58 offset:32
  ds_read_b64 v[104:105], v58 offset:64
  ds_read_b64 v[106:107], v58 offset:96
  ds_read_b64 v[108:109], v58 offset:128
  s_waitcnt lgkmcnt(4)
  v_mfma_f32_16x16x16_bf16 v[80:83], v[100:101], v[212:213], 0
  s_waitcnt lgkmcnt(3)
  v_mfma_f32_16x16x16_bf16 v[80:83], v[102:103], v[214:215], v[80:83]
  s_waitcnt lgkmcnt(2)
  v_mfma_f32_16x16x16_bf16 v[80:83], v[104:105], v[216:217], v[80:83]
  s_waitcnt lgkmcnt(1)
  v_mfma_f32_16x16x16_bf16 v[80:83], v[106:107], v[218:219], v[80:83]
  s_waitcnt lgkmcnt(0)
  v_mfma_f32_16x16x16_bf16 v[80:83], v[108:109], v[220:221], v[80:83]
  s_nop 7
  v_min_u32 v80, -2, v80
  s_cmp_lg_u32 s80, 0
  s_cbranch_scc1 L_pub1_slow
  s_mov_b32 exec_hi, 0xffff
  global_store_dword v59, v80, s[26:27]
  s_mov_b64 exec, -1
  s_branch L_pub1_end
L_pub1_slow:
  s_mov_b32 exec_hi, 0xffff
  global_store_dword v59, v80, s[26:27] sc1
  s_mov_b64 exec, -1
L_pub1_end:
  s_cmp_lg_u32 s3, 7
  s_cbranch_scc1 L_nostats
  v_lshlrev_b32 v24, 16, v28
  v_and_b32 v25, 0xffff0000, v28
  v_lshlrev_b32 v26, 16, v29
  v_and_b32 v27, 0xffff0000, v29
  v_add_f32 v16, v24, v25
  v_add_f32 v17, v26, v27
  v_add_f32 v16, v16, v17
  v_cndmask_b32 v16, 0, v16, s[88:89]
  s_nop 1
  v_add_f32_dpp v17, v16, v16 quad_perm:[1,0,3,2] row_mask:0xf bank_mask:0xf
  s_nop 1
  v_add_f32_dpp v16, v17, v17 quad_perm:[2,3,0,1] row_mask:0xf bank_mask:0xf
  s_nop 1
  v_add_f32_dpp v17, v16, v16 row_half_mirror row_mask:0xf bank_mask:0xf
  s_nop 1
  v_add_f32_dpp v16, v17, v17 row_mirror row_mask:0xf bank_mask:0xf
  v_mov_b32 v17, v16
  s_nop 1
  v_permlane16_swap_b32 v16, v17
  v_add_f32 v16, v16, v17
  v_mul_f32 v18, 0x3c4ccccd, v16
  v_sub_f32 v24, v24, v18
  v_sub_f32 v25, v25, v18
  v_sub_f32 v26, v26, v18
  v_sub_f32 v27, v27, v18
  v_mul_f32 v17, v24, v24
  v_fmac_f32 v17, v25, v25
  v_fmac_f32 v17, v26, v26
  v_fmac_f32 v17, v27, v27
  v_cndmask_b32 v17, 0, v17, s[88:89]
  s_nop 1
  v_add_f32_dpp v18, v17, v17 quad_perm:[1,0,3,2] row_mask:0xf bank_mask:0xf
  s_nop 1
  v_add_f32_dpp v17, v18, v18 quad_perm:[2,3,0,1] row_mask:0xf bank_mask:0xf
  s_nop 1
  v_add_f32_dpp v18, v17, v17 row_half_mirror row_mask:0xf bank_mask:0xf
  s_nop 1
  v_add_f32_dpp v17, v18, v18 row_mirror row_mask:0xf bank_mask:0xf
  v_mov_b32 v18, v17
  s_nop 1
  v_permlane16_swap_b32 v17, v18
  v_add_f32 v17, v17, v18
  v_min_u32 v16, -2, v16
  v_min_u32 v17, -2, v17
  v_lshrrev_b32 v18, 5, v1
  v_lshlrev_b32 v18, 3, v18
  v_add_u32 v18, s94, v18
  s_cmp_lg_u32 s80, 0
  s_cbranch_scc1 L_pub2_slow
  s_mov_b32 exec_lo, 1
  s_mov_b32 exec_hi, 1
  global_store_dwordx2 v18, v[16:17], s[26:27] offset:2048
  s_mov_b64 exec, -1
  s_branch L_pub2_end
L_pub2_slow:
  s_mov_b32 exec_lo, 1
  s_mov_b32 exec_hi, 1
  global_store_dwordx2 v18, v[16:17], s[26:27] offset:2048 sc1
  s_mov_b64 exec, -1
L_pub2_end:
L_nostats:
  s_cmp_ge_u32 s3, 2
  s_cbranch_scc1 L_b5
  s_mul_i32 s92, s64, 18432
  s_add_u32 s92, s92, 786432
  s_add_u32 s92, s92, s80
  s_lshl_b32 s93, s3, 10
  v_and_b32 v24, 7, v1
  v_mul_u32_u24 v24, 2304, v24
  v_add_u32 v24, s92, v24
  s_add_u32 s92, s92, s93
  v_add_u32 v16, s92, v2
  v_add_u32 v17, 2304, v16
  v_add_u32 v18, 4608, v16
  v_add_u32 v19, 6912, v16
  v_add_u32 v20, 9216, v16
  v_add_u32 v21, 11520, v16
  v_add_u32 v22, 13824, v16
  v_add_u32 v23, 16128, v16
  s_mov_b32 s96, 0
  global_load_dwordx4 v[28:31], v24, s[26:27] offset:2048 sc1
  global_load_dwordx4 v[100:103], v16, s[26:27] sc1
  global_load_dwordx4 v[104:107], v17, s[26:27] sc1
  global_load_dwordx4 v[108:111], v18, s[26:27] sc1
  global_load_dwordx4 v[112:115], v19, s[26:27] sc1
  global_load_dwordx4 v[116:119], v20, s[26:27] sc1
  global_load_dwordx4 v[120:123], v21, s[26:27] sc1
  global_load_dwordx4 v[124:127], v22, s[26:27] sc1
  global_load_dwordx4 v[128:131], v23, s[26:27] sc1
L_pg_loop:
  s_waitcnt vmcnt(0)
  v_max_u32 v248, v28, v29
  v_max3_u32 v248, v248, v30, v31
  v_max3_u32 v248, v248, v100, v101
  v_max3_u32 v248, v248, v102, v104
  v_max3_u32 v248, v248, v105, v106
  v_max3_u32 v248, v248, v108, v109
  v_max3_u32 v248, v248, v110, v112
  v_max3_u32 v248, v248, v113, v114
  v_max3_u32 v248, v248, v116, v117
  v_max3_u32 v248, v248, v118, v120
  v_max3_u32 v248, v248, v121, v122
  v_max3_u32 v248, v248, v124, v125
  v_max3_u32 v248, v248, v126, v128
  v_max3_u32 v248, v248, v129, v130
  v_cmp_eq_u32 vcc, -1, v248
  s_nop 0
  s_cmp_eq_u64 vcc, 0
  s_cbranch_scc1 L_pg_ok
  s_add_u32 s96, s96, 1
  s_cmp_gt_u32 s96, 200000
  s_cbranch_scc1 L_pg_ok
  v_max_u32 v248, v28, v29
  v_max3_u32 v248, v248, v30, v31
  v_cmp_eq_u32 vcc, -1, v248
  s_nop 0
  s_cmp_eq_u64 vcc, 0
  s_cbranch_scc1 L_pg_n0
  global_load_dwordx4 v[28:31], v24, s[26:27] offset:2048 sc1
L_pg_n0:
  v_max_u32 v248, v100, v101
  v_max_u32 v248, v248, v102
  v_cmp_eq_u32 vcc, -1, v248
  s_nop 0
  s_cmp_eq_u64 vcc, 0
  s_cbranch_scc1 L_pg_n1
  global_load_dwordx4 v[100:103], v16, s[26:27] sc1
L_pg_n1:
  v_max_u32 v248, v104, v105
  v_max_u32 v248, v248, v106
  v_cmp_eq_u32 vcc, -1, v248
  s_nop 0
  s_cmp_eq_u64 vcc, 0
  s_cbranch_scc1 L_pg_n2
  global_load_dwordx4 v[104:107], v17, s[26:27] sc1
L_pg_n2:
  v_max_u32 v248, v108, v109
  v_max_u32 v248, v248, v110
  v_cmp_eq_u32 vcc, -1, v248
  s_nop 0
  s_cmp_eq_u64 vcc, 0
  s_cbranch_scc1 L_pg_n3
  global_load_dwordx4 v[108:111], v18, s[26:27] sc1
L_pg_n3:
  v_max_u32 v248, v112, v113
  v_max_u32 v248, v248, v114
  v_cmp_eq_u32 vcc, -1, v248
  s_nop 0
  s_cmp_eq_u64 vcc, 0
  s_cbranch_scc1 L_pg_n4
  global_load_dwordx4 v[112:115], v19, s[26:27] sc1
L_pg_n4:
  v_max_u32 v248, v116, v117
  v_max_u32 v248, v248, v118
  v_cmp_eq_u32 vcc, -1, v248
  s_nop 0
  s_cmp_eq_u64 vcc, 0
  s_cbranch_scc1 L_pg_n5
  global_load_dwordx4 v[116:119], v20, s[26:27] sc1
L_pg_n5:
  v_max_u32 v248, v120, v121
  v_max_u32 v248, v248, v122
  v_cmp_eq_u32 vcc, -1, v248
  s_nop 0
  s_cmp_eq_u64 vcc, 0
  s_cbranch_scc1 L_pg_n6
  global_load_dwordx4 v[120:123], v21, s[26:27] sc1
L_pg_n6:
  v_max_u32 v248, v124, v125
  v_max_u32 v248, v248, v126
  v_cmp_eq_u32 vcc, -1, v248
  s_nop 0
  s_cmp_eq_u64 vcc, 0
  s_cbranch_scc1 L_pg_n7
  global_load_dwordx4 v[124:127], v22, s[26:27] sc1
L_pg_n7:
  v_max_u32 v248, v128, v129
  v_max_u32 v248, v248, v130
  v_cmp_eq_u32 vcc, -1, v248
  s_nop 0
  s_cmp_eq_u64 vcc, 0
  s_cbranch_scc1 L_pg_n8
  global_load_dwordx4 v[128:131], v23, s[26:27] sc1
L_pg_n8:
  s_branch L_pg_loop
L_pg_ok:
  v_mov_b32 v32, v28
  v_mov_b32 v33, v30
  v_add_f32 v100, v100, v104
  v_add_f32 v108, v108, v112
  v_add_f32 v101, v101, v105
  v_add_f32 v109, v109, v113
  v_add_f32 v102, v102, v106
  v_add_f32 v110, v110, v114
  v_add_f32_dpp v34, v32, v32 quad_perm:[1,0,3,2] row_mask:0xf bank_mask:0xf
  v_add_f32_dpp v35, v33, v33 quad_perm:[1,0,3,2] row_mask:0xf bank_mask:0xf
  s_nop 0
  v_add_f32_dpp v32, v34, v34 quad_perm:[2,3,0,1] row_mask:0xf bank_mask:0xf
  v_add_f32_dpp v33, v35, v35 quad_perm:[2,3,0,1] row_mask:0xf bank_mask:0xf
  s_nop 0
  v_add_f32_dpp v34, v32, v32 row_half_mirror row_mask:0xf bank_mask:0xf
  v_add_f32_dpp v35, v33, v33 row_half_mirror row_mask:0xf bank_mask:0xf
  v_add_f32 v116, v116, v120
  v_add_f32 v124, v124, v128
  v_add_f32 v117, v117, v121
  v_add_f32 v125, v125, v129
  v_add_f32 v118, v118, v122
  v_add_f32 v126, v126, v130
  v_mul_f32 v34, 0x3acccccd, v34
  v_mul_f32 v35, 0x3acccccd, v35
  v_mul_f32 v32, 0x3c4ccccd, v28
  v_mul_f32 v33, 0x3c4ccccd, v30
  v_sub_f32 v32, v32, v34
  v_sub_f32 v33, v33, v35
  v_mul_f32 v32, v32, v32
  v_mul_f32 v33, v33, v33
  v_mov_b32 v36, 0x42a00000
  v_fma_f32 v32, v32, v36, v29
  v_fma_f32 v33, v33, v36, v31
  v_add_f32 v100, v100, v108
  v_add_f32 v116, v116, v124
  v_add_f32 v101, v101, v109
  v_add_f32 v117, v117, v125
  v_add_f32 v102, v102, v110
  v_add_f32 v118, v118, v126
  v_add_f32_dpp v36, v32, v32 quad_perm:[1,0,3,2] row_mask:0xf bank_mask:0xf
  v_add_f32_dpp v37, v33, v33 quad_perm:[1,0,3,2] row_mask:0xf bank_mask:0xf
  s_nop 0
  v_add_f32_dpp v32, v36, v36 quad_perm:[2,3,0,1] row_mask:0xf bank_mask:0xf
  v_add_f32_dpp v33, v37, v37 quad_perm:[2,3,0,1] row_mask:0xf bank_mask:0xf
  s_nop 0
  v_add_f32_dpp v36, v32, v32 row_half_mirror row_mask:0xf bank_mask:0xf
  v_add_f32_dpp v37, v33, v33 row_half_mirror row_mask:0xf bank_mask:0xf
  v_add_f32 v100, v100, v116
  v_add_f32 v101, v101, v117
  v_add_f32 v102, v102, v118
  v_mul_f32 v36, 0x3acccccd, v36
  v_mul_f32 v37, 0x3acccccd, v37
  v_cvt_pk_bf16_f32 v38, v34, v34
  v_cvt_pk_bf16_f32 v41, v35, v35
  v_cvt_pk_bf16_f32 v32, v36, v36
  v_cvt_pk_bf16_f32 v33, v37, v37
  v_lshlrev_b32 v38, 16, v38
  v_lshlrev_b32 v41, 16, v41
  v_lshlrev_b32 v32, 16, v32
  v_lshlrev_b32 v33, 16, v33
  v_add_f32 v32, 0x3727c5ac, v32
  v_add_f32 v33, 0x3727c5ac, v33
  v_cvt_pk_bf16_f32 v32, v32, v32
  v_cvt_pk_bf16_f32 v33, v33, v33
  v_lshlrev_b32 v32, 16, v32
  v_lshlrev_b32 v33, 16, v33
  v_sqrt_f32 v32, v32
  v_sqrt_f32 v33, v33
  v_fma_f32 v16, -v38, v102, v100
  v_fma_f32 v17, -v41, v102, v101
  v_cvt_pk_bf16_f32 v39, v32, v32
  v_cvt_pk_bf16_f32 v42, v33, v33
  v_lshlrev_b32 v39, 16, v39
  v_lshlrev_b32 v42, 16, v42
  v_rcp_f32 v40, v39
  v_rcp_f32 v43, v42
  v_mul_f32 v24, v16, v40
  v_mul_f32 v25, v17, v43
  v_fma_f32 v28, -v24, v39, v16
  v_fma_f32 v29, -v25, v42, v17
  v_fma_f32 v16, v28, v40, v24
  v_fma_f32 v17, v29, v43, v25
  v_cvt_pk_bf16_f32 v16, v16, v16
  v_cvt_pk_bf16_f32 v17, v17, v17
  v_lshlrev_b32 v16, 16, v16
  v_lshlrev_b32 v17, 16, v17
  v_and_b32 v22, 0x3e, v1
  s_lshl_b32 s93, s3, 6
  v_add_u32 v22, s93, v22
  v_mul_f32_dpp v20, v16, v16 quad_perm:[1,0,3,2] row_mask:0xf bank_mask:0xf
  v_mul_f32_dpp v21, v17, v17 quad_perm:[1,0,3,2] row_mask:0xf bank_mask:0xf
  v_cvt_pk_bf16_f32 v24, v20, v21
  ds_write_b16 v22, v24 offset:18176
  ds_write_b16_d16_hi v22, v24 offset:18304
L_b5:
  s_waitcnt lgkmcnt(0)
  s_barrier
  s_cmp_ge_u32 s3, 5
  s_cbranch_scc1 L_end
  v_bfe_u32 v16, v3, 2, 1
  v_lshlrev_b32 v16, 7, v16
  v_lshl_add_u32 v16, v4, 4, v16
  ds_read_b128 v[100:103], v16 offset:18176
  ds_read_b128 v[104:107], v16 offset:18240
  s_mul_i32 s92, s67, 5
  s_add_u32 s92, s92, s3
  s_mul_i32 s92, s92, 27
  s_add_u32 s92, s92, s64
  s_lshl_b32 s92, s92, 7
  s_add_u32 s92, s92, 1310720
  v_and_b32 v17, 31, v1
  v_lshlrev_b32 v17, 2, v17
  v_add_u32 v17, s92, v17
  s_waitcnt lgkmcnt(1)
  v_mfma_f32_16x16x32_bf16 v[80:83], v[100:103], v[228:231], 0
  s_waitcnt lgkmcnt(0)
  v_mfma_f32_16x16x32_bf16 v[80:83], v[104:107], v[232:235], v[80:83]
  s_nop 7
  v_min_u32 v80, -2, v80
  s_mov_b32 exec_hi, 0
  global_store_dword v17, v80, s[26:27] sc1
  s_mov_b32 exec_hi, -1
L_end:
  s_endpgm
.section .rodata,"a"
.p2align 6
.amdhsa_kernel sequential_preLN__mha_block_cached__glu_gated_bilinear__decode_kernel
  .amdhsa_next_free_vgpr 256
  .amdhsa_next_free_sgpr 102
  .amdhsa_accum_offset 256
  .amdhsa_group_segment_fixed_size 0
  .amdhsa_kernarg_size 96
  .amdhsa_user_sgpr_count 2
  .amdhsa_user_sgpr_kernarg_segment_ptr 1
  .amdhsa_system_sgpr_workgroup_id_x 1
  .amdhsa_float_denorm_mode_32 3
.end_amdhsa_kernel
```
